```python
import torch

def _softmax(x, axis=-1):
    return torch.softmax(x, dim=axis)
def _gelu(x):
    return torch.nn.functional.gelu(x, approximate="tanh")
def _silu(x):
    return torch.nn.functional.silu(x)
def _sigmoid(x):
    return torch.sigmoid(x)
def _layernorm(x, axis=-1, eps=1e-5):
    m = x.mean(dim=axis, keepdim=True)
    v = x.var(dim=axis, keepdim=True, unbiased=False)
    return (x - m) / torch.sqrt(v + eps)
def _scatter_add(tgt, idx, src, axis=0):
    return tgt.clone().index_add_(axis, idx, src)
def _segment_sum(src, seg, n):
    out = torch.zeros((n,) + src.shape[1:], dtype=src.dtype)
    return out.index_add_(0, seg, src)
def _pad(x, pw):
    flat = tuple(v for pair in reversed(pw) for v in pair)
    return torch.nn.functional.pad(x, flat)

kernel_name = 'parallel_sum__sliding_block_cached__geglu_ffn__decode'

def setup_inputs():

    _w = (lambda a: (lambda t: t.to(torch.bfloat16) if t.is_floating_point() else t)(torch.as_tensor(a)))
    def _A_setup():
        B, Sq, D = 1, 1, 1024
        Hq, Hkv, Sk, Dh = 32, 4, 65536, 128
        assert Hq % Hkv == 0, (Hq, Hkv)
        return {
            "x": _w((lambda *s: torch.randn(*s, dtype=torch.bfloat16) * 0.05)(B, Sq, D)),
            "k_cache": _w((lambda *s: torch.randn(*s, dtype=torch.bfloat16) * 3.2)(B, Hkv, Sk, Dh)),
            "v_cache": _w((lambda *s: torch.randn(*s, dtype=torch.bfloat16) * 1.6)(B, Hkv, Sk, Dh)),
            "wq": _w((lambda *s: torch.randn(*s, dtype=torch.bfloat16) * 3.2)(D, Hq * Dh) * (D ** -0.5)),
            "wo": _w((lambda *s: torch.randn(*s, dtype=torch.bfloat16) * 1.6)(Hq * Dh, D) * ((Hq * Dh) ** -0.5)),
        }
    _A_in = _A_setup()

    def _B_setup():
        B, S, D, F = 1, 1, 1024, 3584
        return {
            "x": _w((lambda *s: torch.randn(*s, dtype=torch.bfloat16) * 0.05)(B, S, D)),
            "w_gate": _w((lambda *s: torch.randn(*s, dtype=torch.bfloat16) * 0.05)(D, F)),
            "w_up": _w((lambda *s: torch.randn(*s, dtype=torch.bfloat16) * 0.05)(D, F)),
            "w_down": _w((lambda *s: torch.randn(*s, dtype=torch.bfloat16) * 0.05)(F, D)),
        }
    _B_in = _B_setup()

    return {
        "A_x": _A_in["x"],
        "A_k_cache": _A_in["k_cache"],
        "A_v_cache": _A_in["v_cache"],
        "A_wq": _A_in["wq"],
        "A_wo": _A_in["wo"],
        "B_x": _B_in["x"],
        "B_w_gate": _B_in["w_gate"],
        "B_w_up": _B_in["w_up"],
        "B_w_down": _B_in["w_down"],
    }

def reference(A_x, A_k_cache, A_v_cache, A_wq, A_wo, B_x, B_w_gate, B_w_up, B_w_down):
    def _A_ref(x, k_cache, v_cache, wq, wo):
        B, Sq, D = x.shape
        Hq, Dh = 32, 128
        Hkv, Sk = k_cache.shape[1], k_cache.shape[2]
        W = min(4096, max(256, Sk // 4))
        rep = Hq // Hkv
        q = (lambda x, *d: x.permute(*d))((x @ wq).reshape(B, Sq, Hq, Dh), 0, 2, 1, 3)
        k = (lambda x, n, axis: torch.repeat_interleave(x, n, dim=axis))(k_cache[:, :, Sk - W:, :], rep, axis=1)
        v = (lambda x, n, axis: torch.repeat_interleave(x, n, dim=axis))(v_cache[:, :, Sk - W:, :], rep, axis=1)
        scores = torch.einsum("bhqd,bhkd->bhqk", q, k) * (Dh ** -0.5)
        p = _softmax(scores, axis=-1)
        o = torch.einsum("bhqk,bhkd->bhqd", p, v)
        return (lambda x, *d: x.permute(*d))(o, 0, 2, 1, 3).reshape(B, Sq, Hq * Dh) @ wo

    def _B_ref(x, w_gate, w_up, w_down):
        return (_gelu(x @ w_gate) * (x @ w_up)) @ w_down

    x = A_x
    xn = _layernorm(x, axis=-1)
    return x + _A_ref(xn, A_k_cache, A_v_cache, A_wq, A_wo) + _B_ref(xn, B_w_gate, B_w_up, B_w_down)
```

```asm
; @launch grid=(256,1,1) block=(512,1,1) lds=145920
.amdgcn_target "amdgcn-amd-amdhsa--gfx950"
.text
.p2align 12
.globl parallel_sum__sliding_block_cached__geglu_ffn__decode_kernel
.p2align 8
.type parallel_sum__sliding_block_cached__geglu_ffn__decode_kernel,@function
parallel_sum__sliding_block_cached__geglu_ffn__decode_kernel:
    s_cmp_lt_u32 s2, 64
    s_cselect_b32 s4, 8, 24
    s_load_dwordx2 s[16:17], s[0:1], s4
    s_load_dwordx2 s[8:9], s[0:1], 0
    s_load_dwordx2 s[12:13], s[0:1], 88
    v_lshrrev_b32 v4, 6, v0
    s_cselect_b32 s57, 16, 48
    s_cselect_b32 s18, 8, 1
    v_readfirstlane_b32 s3, v4
    s_lshl_b32 s18, s18, 23
    s_mov_b32 s19, 0x20000
    s_cmp_ge_u32 s2, 256
    s_cbranch_scc1 L_end
    s_xor_b32 s3, s3, 4
    v_and_b32 v2, 15, v0
    v_bfe_u32 v3, v0, 4, 2
    v_and_b32 v1, 63, v0
    s_cmp_lt_u32 s2, 64
    s_cbranch_scc1 L_A
    s_sub_u32 s49, s2, 64
    s_lshr_b32 s96, s49, 6
    s_and_b32 s97, s49, 63
    s_cmp_lt_u32 s3, 4
    s_cbranch_scc1 L_PS
L_PH:
    s_getpc_b64 s[6:7]
    v_min_u32 v5, 7, v2
    v_mad_u32_u24 v5, v4, 8, v5
    s_bfe_u32 s48, s2, 0x20003
    s_mul_i32 s48, s48, 32
    v_add_lshl_u32 v5, v5, s48, 7
    global_load_dword v255, v5, s[6:7]
    s_setprio 2
    s_mov_b32 s10, 0x800
    s_mov_b32 s11, 0x20000
    v_lshlrev_b32 v4, 5, v1
    v_mul_u32_u24 v5, 12, v1
    s_mul_i32 s5, s96, 704
    s_cmp_lg_u32 s3, 4
    s_waitcnt lgkmcnt(0)
    s_cbranch_scc1 L_PH0
    buffer_load_dwordx4 v[20:23], v4, s[8:11], 0 offen
    buffer_load_dwordx4 v[24:27], v4, s[8:11], 0 offen offset:16
    buffer_load_dwordx3 v[28:30], v5, s[8:11], s5 offen
L_PH0:
    s_branch L_PH1
L_PS:
    s_mul_i32 s5, s96, 352
    s_lshl_b32 s6, s3, 3
    s_add_u32 s59, s5, s6
    s_lshl_b32 s7, s97, 7
    s_xor_b32 s4, s7, 0
    s_lshl_b32 s48, s59, 13
    s_add_u32 s48, s48, s4
    s_lshr_b32 s5, s97, 3
    s_lshl_b32 s5, s5, 2
    s_lshr_b32 s5, 0x76543210, s5
    s_and_b32 s53, s5, 15
    s_add_u32 s54, s48, 2883584
    s_lshl_b32 s5, s53, 18
    s_add_u32 s48, s48, s5
    v_bfe_u32 v6, v0, 3, 3
    v_and_b32 v5, 7, v0
    v_lshlrev_b32 v5, 4, v5
    v_lshl_add_u32 v13, v6, 13, v5
    s_waitcnt lgkmcnt(0)
    buffer_load_dwordx4 v[120:123], v13, s[16:19], s48 offen nt
    s_add_u32 s48, s48, 262144
    s_cmp_ge_u32 s48, s54
    s_cselect_b32 s4, 2883584, 0
    s_sub_u32 s48, s48, s4
    buffer_load_dwordx4 v[124:127], v13, s[16:19], s48 offen nt
    s_add_u32 s48, s48, 262144
    s_cmp_ge_u32 s48, s54
    s_cselect_b32 s4, 2883584, 0
    s_sub_u32 s48, s48, s4
    buffer_load_dwordx4 v[128:131], v13, s[16:19], s48 offen nt
    s_add_u32 s48, s48, 262144
    s_cmp_ge_u32 s48, s54
    s_cselect_b32 s4, 2883584, 0
    s_sub_u32 s48, s48, s4
    buffer_load_dwordx4 v[132:135], v13, s[16:19], s48 offen nt
    s_add_u32 s48, s48, 262144
    s_cmp_ge_u32 s48, s54
    s_cselect_b32 s4, 2883584, 0
    s_sub_u32 s48, s48, s4
    buffer_load_dwordx4 v[136:139], v13, s[16:19], s48 offen nt
    s_add_u32 s48, s48, 262144
    s_cmp_ge_u32 s48, s54
    s_cselect_b32 s4, 2883584, 0
    s_sub_u32 s48, s48, s4
    buffer_load_dwordx4 v[140:143], v13, s[16:19], s48 offen nt
    s_add_u32 s48, s48, 262144
    s_cmp_ge_u32 s48, s54
    s_cselect_b32 s4, 2883584, 0
    s_sub_u32 s48, s48, s4
    s_branch L_PS1
L_A:
    s_and_b32 s96, s2, 3
    s_lshr_b32 s97, s2, 2
    s_mul_i32 s4, s96, 16785408
    s_lshl_b32 s5, s97, 16
    s_add_u32 s4, s4, s5
    s_lshl_b32 s5, s3, 10
    s_add_u32 s4, s4, s5
    s_add_u32 s48, s4, 15728640
    s_lshl_b32 s50, s3, 13
    v_lshlrev_b32 v4, 8, v3
    v_xor_b32 v5, v3, v2
    v_lshl_add_u32 v24, v5, 4, v4
    v_xor_b32 v25, 64, v24
    v_xor_b32 v26, 128, v24
    v_xor_b32 v27, 192, v24
    s_waitcnt lgkmcnt(0)
    s_add_u32 m0, s50, 0
    s_xor_b32 s49, s48, 0
    buffer_load_dwordx4 v24, s[16:19], s49 offen nt lds
    s_add_u32 m0, s50, 1024
    s_xor_b32 s49, s48, 8192
    buffer_load_dwordx4 v25, s[16:19], s49 offen nt lds
    s_add_u32 m0, s50, 2048
    s_xor_b32 s49, s48, 16384
    buffer_load_dwordx4 v26, s[16:19], s49 offen nt lds
    s_add_u32 m0, s50, 3072
    s_xor_b32 s49, s48, 24576
    buffer_load_dwordx4 v27, s[16:19], s49 offen nt lds
    s_add_u32 m0, s50, 4096
    s_xor_b32 s49, s48, 32768
    buffer_load_dwordx4 v24, s[16:19], s49 offen nt lds
    s_cmp_ge_u32 s3, 4
    s_cbranch_scc1 L_AH1
    s_branch L_AS1
L_PH1:
    s_load_dwordx2 s[20:21], s[0:1], s57
    s_load_dwordx2 s[24:25], s[0:1], 56
    s_load_dwordx2 s[28:29], s[0:1], 32
    s_load_dwordx2 s[32:33], s[0:1], 64
    s_load_dwordx2 s[36:37], s[0:1], 72
    s_load_dword s56, s[12:13], 0
    s_mov_b32 s14, 0x200000
    s_mov_b32 s15, 0x20000
    s_mov_b32 s44, 0x7060500
    s_mov_b32 s45, 0x7060501
    s_mov_b32 s46, 0x7060502
    s_mov_b32 s47, 0x7060503
    s_mov_b32 s98, 0x3fb8aa3b
    s_mov_b32 s99, 0xffff0000
    s_cmp_lg_u32 s3, 4
    s_cbranch_scc1 L_PH2
    v_mov_b32 v6, 0
    v_mov_b32 v7, 0
    v_mov_b32 v4, 140544
    ds_write_b64 v4, v[6:7]
    ds_write_b64 v4, v[6:7] offset:8
    ds_write_b64 v4, v[6:7] offset:16
    ds_write_b64 v4, v[6:7] offset:24
    v_lshlrev_b32 v13, 1, v5
    s_waitcnt vmcnt(1)
    v_lshlrev_b32 v32, 16, v20
    v_and_b32 v33, s99, v20
    v_lshlrev_b32 v34, 16, v21
    v_and_b32 v35, s99, v21
    v_lshlrev_b32 v36, 16, v22
    v_and_b32 v37, s99, v22
    v_lshlrev_b32 v38, 16, v23
    v_and_b32 v39, s99, v23
    v_lshlrev_b32 v40, 16, v24
    v_and_b32 v41, s99, v24
    v_lshlrev_b32 v42, 16, v25
    v_and_b32 v43, s99, v25
    v_lshlrev_b32 v44, 16, v26
    v_and_b32 v45, s99, v26
    v_lshlrev_b32 v46, 16, v27
    v_and_b32 v47, s99, v27
    v_pk_add_f32 v[20:21], v[32:33], v[40:41]
    v_pk_add_f32 v[22:23], v[34:35], v[42:43]
    v_pk_add_f32 v[24:25], v[36:37], v[44:45]
    v_pk_add_f32 v[26:27], v[38:39], v[46:47]
    v_pk_add_f32 v[20:21], v[20:21], v[24:25]
    v_pk_add_f32 v[22:23], v[22:23], v[26:27]
    v_pk_add_f32 v[20:21], v[20:21], v[22:23]
    v_add_f32 v4, v20, v21
    s_nop 1
    v_add_f32_dpp v4, v4, v4 row_ror:1 row_mask:0xf bank_mask:0xf
    s_nop 1
    v_add_f32_dpp v4, v4, v4 row_ror:2 row_mask:0xf bank_mask:0xf
    s_nop 1
    v_add_f32_dpp v4, v4, v4 row_ror:4 row_mask:0xf bank_mask:0xf
    s_nop 1
    v_add_f32_dpp v4, v4, v4 row_ror:8 row_mask:0xf bank_mask:0xf
    v_mov_b32 v5, v4
    s_nop 1
    v_permlane16_swap_b32 v4, v5
    v_add_f32 v4, v4, v5
    v_mov_b32 v5, v4
    s_nop 1
    v_permlane32_swap_b32 v4, v5
    v_add_f32 v4, v4, v5
    v_mul_f32 v4, 0x3a800000, v4
    v_pk_add_f32 v[32:33], v[32:33], v[4:5] op_sel_hi:[1,0] neg_lo:[0,1] neg_hi:[0,1]
    v_pk_add_f32 v[34:35], v[34:35], v[4:5] op_sel_hi:[1,0] neg_lo:[0,1] neg_hi:[0,1]
    v_pk_add_f32 v[36:37], v[36:37], v[4:5] op_sel_hi:[1,0] neg_lo:[0,1] neg_hi:[0,1]
    v_pk_add_f32 v[38:39], v[38:39], v[4:5] op_sel_hi:[1,0] neg_lo:[0,1] neg_hi:[0,1]
    v_pk_add_f32 v[40:41], v[40:41], v[4:5] op_sel_hi:[1,0] neg_lo:[0,1] neg_hi:[0,1]
    v_pk_add_f32 v[42:43], v[42:43], v[4:5] op_sel_hi:[1,0] neg_lo:[0,1] neg_hi:[0,1]
    v_pk_add_f32 v[44:45], v[44:45], v[4:5] op_sel_hi:[1,0] neg_lo:[0,1] neg_hi:[0,1]
    v_pk_add_f32 v[46:47], v[46:47], v[4:5] op_sel_hi:[1,0] neg_lo:[0,1] neg_hi:[0,1]
    v_pk_mul_f32 v[20:21], v[32:33], v[32:33]
    v_pk_mul_f32 v[22:23], v[34:35], v[34:35]
    v_pk_fma_f32 v[20:21], v[36:37], v[36:37], v[20:21]
    v_pk_fma_f32 v[22:23], v[38:39], v[38:39], v[22:23]
    v_pk_fma_f32 v[20:21], v[40:41], v[40:41], v[20:21]
    v_pk_fma_f32 v[22:23], v[42:43], v[42:43], v[22:23]
    v_pk_fma_f32 v[20:21], v[44:45], v[44:45], v[20:21]
    v_pk_fma_f32 v[22:23], v[46:47], v[46:47], v[22:23]
    v_pk_add_f32 v[20:21], v[20:21], v[22:23]
    v_add_f32 v6, v20, v21
    v_cvt_pk_bf16_f32 v4, v4, v4
    v_lshlrev_b32 v4, 16, v4
    s_waitcnt vmcnt(0)
    v_add_f32_dpp v6, v6, v6 row_ror:1 row_mask:0xf bank_mask:0xf
    s_nop 1
    v_add_f32_dpp v6, v6, v6 row_ror:2 row_mask:0xf bank_mask:0xf
    s_nop 1
    v_add_f32_dpp v6, v6, v6 row_ror:4 row_mask:0xf bank_mask:0xf
    s_nop 1
    v_add_f32_dpp v6, v6, v6 row_ror:8 row_mask:0xf bank_mask:0xf
    v_lshlrev_b32 v48, 16, v28
    v_and_b32 v49, s99, v28
    v_lshlrev_b32 v50, 16, v29
    v_and_b32 v51, s99, v29
    v_lshlrev_b32 v52, 16, v30
    v_and_b32 v53, s99, v30
    v_mov_b32 v5, v6
    s_nop 1
    v_permlane16_swap_b32 v6, v5
    v_add_f32 v6, v6, v5
    v_sub_f32 v48, v48, v4
    v_sub_f32 v49, v49, v4
    v_sub_f32 v50, v50, v4
    v_sub_f32 v51, v51, v4
    v_sub_f32 v52, v52, v4
    v_sub_f32 v53, v53, v4
    v_mov_b32 v5, v6
    s_nop 1
    v_permlane32_swap_b32 v6, v5
    v_add_f32 v6, v6, v5
    v_cvt_pk_bf16_f32 v28, v48, v49
    v_cvt_pk_bf16_f32 v29, v50, v51
    v_cvt_pk_bf16_f32 v30, v52, v53
    v_mul_f32 v6, 0x3a800000, v6
    v_cvt_pk_bf16_f32 v6, v6, v6
    v_lshlrev_b32 v6, 16, v6
    v_add_f32 v6, 0x3727c5ac, v6
    v_cvt_pk_bf16_f32 v6, v6, v6
    v_lshlrev_b32 v6, 16, v6
    v_sqrt_f32 v6, v6
    v_lshlrev_b32 v48, 16, v28
    v_and_b32 v49, s99, v28
    v_lshlrev_b32 v50, 16, v29
    v_and_b32 v51, s99, v29
    v_lshlrev_b32 v52, 16, v30
    v_and_b32 v53, s99, v30
    v_cvt_pk_bf16_f32 v6, v6, v6
    v_lshlrev_b32 v6, 16, v6
    v_rcp_f32 v7, v6
    s_nop 0
    v_mul_f32 v32, v48, v7
    v_mul_f32 v33, v49, v7
    v_mul_f32 v34, v50, v7
    v_mul_f32 v35, v51, v7
    v_mul_f32 v36, v52, v7
    v_mul_f32 v37, v53, v7
    v_fma_f32 v48, -v32, v6, v48
    v_fma_f32 v49, -v33, v6, v49
    v_fma_f32 v50, -v34, v6, v50
    v_fma_f32 v51, -v35, v6, v51
    v_fma_f32 v52, -v36, v6, v52
    v_fma_f32 v53, -v37, v6, v53
    v_fmac_f32 v32, v48, v7
    v_fmac_f32 v33, v49, v7
    v_fmac_f32 v34, v50, v7
    v_fmac_f32 v35, v51, v7
    v_fmac_f32 v36, v52, v7
    v_fmac_f32 v37, v53, v7
    v_cvt_pk_bf16_f32 v32, v32, v32
    v_cvt_pk_bf16_f32 v33, v33, v33
    v_cvt_pk_bf16_f32 v34, v34, v34
    v_cvt_pk_bf16_f32 v35, v35, v35
    v_cvt_pk_bf16_f32 v36, v36, v36
    v_cvt_pk_bf16_f32 v37, v37, v37
    ds_write_b64 v13, v[32:33] offset:0
    ds_write_b64 v13, v[34:35] offset:8
    ds_write_b64 v13, v[36:37] offset:16
    ds_write_b64 v13, v[32:33] offset:1408
    ds_write_b64 v13, v[34:35] offset:1416
    ds_write_b64 v13, v[36:37] offset:1424
L_PH2:
    s_waitcnt lgkmcnt(0)
    s_add_u32 s56, s56, 0x01010101
    v_mov_b32 v12, s56
    s_bfe_u32 s40, s56, 0x80000
    s_bfe_u32 s41, s56, 0x80008
    s_bfe_u32 s42, s56, 0x80010
    s_bfe_u32 s43, s56, 0x80018
    s_barrier
    s_cmp_lg_u32 s3, 7
    s_cbranch_scc1 L_PH7
    s_lshr_b32 s4, s2, 3
    s_and_b32 s5, s2, 7
    s_lshl_b32 s5, s5, 9
    s_lshl_b32 s4, s4, 4
    s_add_u32 s4, s4, s5
    s_add_u32 s4, s4, 589824
    s_getreg_b32 s5, hwreg(HW_REG_XCC_ID, 0, 4)
    s_lshl_b32 s5, s5, 8
    s_or_b32 s6, s5, s40
    v_mov_b32 v20, s6
    s_or_b32 s6, s5, s41
    v_mov_b32 v21, s6
    s_or_b32 s6, s5, s42
    v_mov_b32 v22, s6
    s_or_b32 s6, s5, s43
    v_mov_b32 v23, s6
    v_mov_b32 v4, 0
    s_mov_b64 exec, 1
    buffer_store_dwordx4 v[20:23], v4, s[12:15], s4 offen sc1
    s_mov_b64 exec, -1
L_PH7:
    v_lshlrev_b32 v4, 4, v2
    v_and_b32 v5, 1, v3
    v_lshl_add_u32 v13, v5, 11, v4
    s_lshl_b32 s4, s97, 8
    s_xor_b32 s5, s97, 3
    s_and_b32 s58, s5, 7
    s_cmp_eq_u32 s58, 3
    s_addc_u32 s6, s5, 0
    s_cmp_eq_u32 s58, 4
    s_subb_u32 s5, s5, 0
    s_cmp_eq_u32 s58, 4
    s_cselect_b32 s7, 43008, 0
    s_lshl_b32 s5, s5, 8
    s_lshl_b32 s6, s6, 8
    s_add_u32 s5, s5, s7
    s_add_u32 s6, s6, 43008
    s_sub_u32 s6, s6, s7
    s_sub_u32 s6, s6, s5
    v_mul_i32_i24 v5, s6, v5
    v_add_u32 v14, v5, v4
    v_add_u32 v14, s5, v14
    s_mov_b32 s5, 0
    v_lshlrev_b32 v15, 4, v2
    s_xor_b32 s4, s4, 0
    s_lshl_b32 s53, s96, 14
    s_add_u32 s53, s53, s4
    s_add_u32 s53, s53, 65536
    s_mul_i32 s54, s96, 14336
    s_add_u32 s54, s54, s5
    s_add_u32 s54, s54, 131072
    s_barrier
    s_cmp_lg_u32 s3, 5
    s_cbranch_scc1 L_PH3
    s_bfm_b64 exec, 16, 0
    ds_read_b128 v[20:23], v13 offset:4096
    ds_read_b128 v[24:27], v13 offset:4352
    ds_read_b128 v[28:31], v13 offset:4608
    ds_read_b128 v[32:35], v13 offset:4864
    ds_read_b128 v[36:39], v13 offset:5120
    ds_read_b128 v[40:43], v13 offset:5376
    ds_read_b128 v[44:47], v13 offset:5632
    ds_read_b128 v[48:51], v13 offset:5888
    s_waitcnt lgkmcnt(6)
    v_pk_add_f32 v[20:21], v[20:21], v[24:25]
    v_pk_add_f32 v[22:23], v[22:23], v[26:27]
    s_waitcnt lgkmcnt(4)
    v_pk_add_f32 v[28:29], v[28:29], v[32:33]
    v_pk_add_f32 v[30:31], v[30:31], v[34:35]
    s_waitcnt lgkmcnt(2)
    v_pk_add_f32 v[36:37], v[36:37], v[40:41]
    v_pk_add_f32 v[38:39], v[38:39], v[42:43]
    s_waitcnt lgkmcnt(0)
    v_pk_add_f32 v[44:45], v[44:45], v[48:49]
    v_pk_add_f32 v[46:47], v[46:47], v[50:51]
    v_pk_add_f32 v[20:21], v[20:21], v[28:29]
    v_pk_add_f32 v[22:23], v[22:23], v[30:31]
    v_pk_add_f32 v[36:37], v[36:37], v[44:45]
    v_pk_add_f32 v[38:39], v[38:39], v[46:47]
    v_pk_add_f32 v[20:21], v[20:21], v[36:37]
    v_pk_add_f32 v[22:23], v[22:23], v[38:39]
    v_add_u32 v20, 0x80, v20
    v_add_u32 v21, 0x80, v21
    v_add_u32 v22, 0x80, v22
    v_add_u32 v23, 0x80, v23
    v_perm_b32 v20, v20, v12, s44
    v_perm_b32 v21, v21, v12, s45
    v_perm_b32 v22, v22, v12, s46
    v_perm_b32 v23, v23, v12, s47
    buffer_store_dwordx4 v[20:23], v15, s[12:15], s53 offen sc1
    s_mov_b64 exec, -1
L_PH3:
    s_barrier
    s_cmp_lg_u32 s3, 7
    s_cbranch_scc1 L_HELP
    s_cmp_ge_u32 s97, 56
    s_cbranch_scc1 L_HELP
    s_bfm_b64 exec, 32, 0
    ds_read_b128 v[20:23], v13 offset:6144
    ds_read_b128 v[24:27], v13 offset:6400
    ds_read_b128 v[28:31], v13 offset:6656
    ds_read_b128 v[32:35], v13 offset:6912
    ds_read_b128 v[36:39], v13 offset:7168
    ds_read_b128 v[40:43], v13 offset:7424
    ds_read_b128 v[44:47], v13 offset:7680
    ds_read_b128 v[48:51], v13 offset:7936
    s_waitcnt lgkmcnt(6)
    v_pk_add_f32 v[20:21], v[20:21], v[24:25]
    v_pk_add_f32 v[22:23], v[22:23], v[26:27]
    s_waitcnt lgkmcnt(4)
    v_pk_add_f32 v[28:29], v[28:29], v[32:33]
    v_pk_add_f32 v[30:31], v[30:31], v[34:35]
    s_waitcnt lgkmcnt(2)
    v_pk_add_f32 v[36:37], v[36:37], v[40:41]
    v_pk_add_f32 v[38:39], v[38:39], v[42:43]
    s_waitcnt lgkmcnt(0)
    v_pk_add_f32 v[44:45], v[44:45], v[48:49]
    v_pk_add_f32 v[46:47], v[46:47], v[50:51]
    v_pk_add_f32 v[20:21], v[20:21], v[28:29]
    v_pk_add_f32 v[22:23], v[22:23], v[30:31]
    v_pk_add_f32 v[36:37], v[36:37], v[44:45]
    v_pk_add_f32 v[38:39], v[38:39], v[46:47]
    v_pk_add_f32 v[20:21], v[20:21], v[36:37]
    v_pk_add_f32 v[22:23], v[22:23], v[38:39]
    v_add_u32 v20, 0x80, v20
    v_add_u32 v21, 0x80, v21
    v_add_u32 v22, 0x80, v22
    v_add_u32 v23, 0x80, v23
    v_perm_b32 v20, v20, v12, s44
    v_perm_b32 v21, v21, v12, s45
    v_perm_b32 v22, v22, v12, s46
    v_perm_b32 v23, v23, v12, s47
    buffer_store_dwordx4 v[20:23], v14, s[12:15], s54 offen sc1
    s_mov_b64 exec, -1
    s_branch L_HELP
L_PS1:
    s_load_dwordx2 s[20:21], s[0:1], s57
    s_load_dwordx2 s[24:25], s[0:1], 56
    s_load_dwordx2 s[28:29], s[0:1], 32
    s_load_dwordx2 s[32:33], s[0:1], 64
    s_load_dwordx2 s[36:37], s[0:1], 72
    s_waitcnt lgkmcnt(0)
    s_load_dword s56, s[12:13], 0
    s_mul_i32 s5, s59, 7168
    s_xor_b32 s49, s97, 3
    s_and_b32 s58, s49, 7
    s_cmp_eq_u32 s58, 3
    s_addc_u32 s50, s49, 0
    s_cmp_eq_u32 s58, 4
    s_subb_u32 s49, s49, 0
    s_cmp_eq_u32 s58, 4
    s_cselect_b64 s[62:63], s[24:25], s[20:21]
    s_cselect_b64 s[24:25], s[20:21], s[24:25]
    s_mov_b64 s[20:21], s[62:63]
    s_lshl_b32 s49, s49, 7
    s_add_u32 s49, s49, s5
    s_lshl_b32 s50, s50, 7
    s_add_u32 s50, s50, s5
    s_add_u32 s55, s49, 2523136
    s_add_u32 s59, s50, 2523136
    s_mul_i32 s5, s53, 229376
    s_add_u32 s49, s49, s5
    s_add_u32 s50, s50, s5
    s_lshl_b32 s5, s53, 5
    s_add_u32 s6, s6, s5
    v_mul_u32_u24 v7, 7168, v6
    v_add_u32 v14, v7, v5
    s_lshl_b32 s6, s6, 2
    v_lshl_add_u32 v19, v6, 2, s6
    s_cmp_lt_u32 s97, 56
    s_cselect_b32 s22, 0x700000, 0
    s_mov_b32 s23, 0x20000
    s_mov_b32 s26, s22
    s_mov_b32 s27, 0x20000
    s_mov_b32 s30, 0x800000
    s_mov_b32 s31, 0x20000
    s_mov_b32 s34, 0x700000
    s_mov_b32 s35, 0x20000
    s_mov_b32 s38, 0x800
    s_mov_b32 s39, 0x20000
    s_mov_b32 s10, 0x800
    s_mov_b32 s11, 0x20000
    s_mov_b32 s14, 0x200000
    s_mov_b32 s15, 0x20000
    s_mov_b32 s44, 0x7060500
    s_mov_b32 s45, 0x7060501
    s_mov_b32 s46, 0x7060502
    s_mov_b32 s47, 0x7060503
    s_mov_b32 s98, 0x3fb8aa3b
    s_mov_b32 s99, 0xffff0000
    v_and_b32 v4, 1, v0
    v_lshlrev_b32 v4, 4, v4
    v_mov_b32 v5, 0xffff
    v_lshlrev_b32 v4, v4, v5
    v_bfe_u32 v5, v0, 1, 2
    v_cmp_eq_u32 vcc, 0, v5
    s_nop 1
    v_cndmask_b32 v8, 0, v4, vcc
    v_cmp_eq_u32 vcc, 1, v5
    s_nop 1
    v_cndmask_b32 v9, 0, v4, vcc
    v_cmp_eq_u32 vcc, 2, v5
    s_nop 1
    v_cndmask_b32 v10, 0, v4, vcc
    v_cmp_eq_u32 vcc, 3, v5
    s_nop 1
    v_cndmask_b32 v11, 0, v4, vcc
    s_lshr_b32 s4, s2, 3
    s_and_b32 s5, s2, 7
    s_lshl_b32 s7, s5, 8
    s_lshl_b32 s6, s3, 13
    s_add_u32 s7, s7, s6
    s_mul_i32 s6, s4, 7
    s_lshl_b32 s52, s6, 15
    s_add_u32 s52, s52, s7
    s_lshr_b32 s4, s2, 3
    s_and_b32 s5, s2, 7
    s_lshl_b32 s7, s5, 8
    s_lshl_b32 s6, s3, 13
    s_add_u32 s7, s7, s6
    s_lshl_b32 s51, s4, 18
    s_add_u32 s51, s51, s7
    v_lshlrev_b32 v4, 4, v2
    v_lshl_add_u32 v15, v3, 11, v4
    s_lshl_b32 s4, s3, 4
    s_add_u32 s4, s4, 137984
    v_lshl_add_u32 v20, v3, 2, s4
    v_mov_b32 v22, 140544
    v_and_b32 v4, 1, v3
    v_lshlrev_b32 v4, 4, v4
    v_lshl_add_u32 v4, v2, 5, v4
    s_lshl_b32 s4, s3, 9
    s_add_u32 s4, s4, 140608
    v_add_u32 v17, s4, v4
    v_lshrrev_b32 v4, 1, v3
    v_lshlrev_b32 v4, 8, v4
    v_and_b32 v5, 1, v3
    v_lshl_add_u32 v4, v5, 4, v4
    v_and_b32 v5, 7, v0
    v_lshl_add_u32 v4, v5, 5, v4
    s_lshl_b32 s4, s3, 9
    s_add_u32 s4, s4, 4096
    v_add_u32 v18, s4, v4
    s_mov_b32 s60, 0x00ff00ff
    s_mov_b32 s61, 0xff00ff00
    s_lshl_b32 s4, s3, 10
    s_add_u32 s4, s4, 12288
    v_lshl_add_u32 v4, v1, 4, s4
    v_cndmask_b32 v18, v4, v18, s[60:61]
    s_waitcnt lgkmcnt(0)
    s_add_u32 s56, s56, 0x01010101
    v_mov_b32 v12, s56
    s_bfe_u32 s40, s56, 0x80000
    s_bfe_u32 s41, s56, 0x80008
    s_bfe_u32 s42, s56, 0x80010
    s_bfe_u32 s43, s56, 0x80018
    s_waitcnt vmcnt(5)
    s_waitcnt vmcnt(4)
    buffer_load_dwordx4 v[144:147], v13, s[16:19], s48 offen nt
    s_add_u32 s48, s48, 262144
    s_cmp_ge_u32 s48, s54
    s_cselect_b32 s4, 2883584, 0
    s_sub_u32 s48, s48, s4
    s_waitcnt vmcnt(4)
    buffer_load_dwordx4 v[148:151], v13, s[16:19], s48 offen nt
    s_add_u32 s48, s48, 262144
    s_cmp_ge_u32 s48, s54
    s_cselect_b32 s4, 2883584, 0
    s_sub_u32 s48, s48, s4
    s_waitcnt vmcnt(4)
    buffer_load_dwordx4 v[152:155], v13, s[16:19], s48 offen nt
    s_add_u32 s48, s48, 262144
    s_cmp_ge_u32 s48, s54
    s_cselect_b32 s4, 2883584, 0
    s_sub_u32 s48, s48, s4
    s_barrier
    ds_read2_b32 v[54:55], v19 offset0:0 offset1:32
    ds_read2_b32 v[56:57], v19 offset0:64 offset1:96
    ds_read2_b32 v[58:59], v19 offset0:128 offset1:160
    ds_read2_b32 v[60:61], v19 offset0:192 offset1:224
    ds_read_b32 v62, v19 offset:1024
    ds_read_b32 v63, v19 offset:1152
    ds_read_b32 v64, v19 offset:1280
    s_waitcnt lgkmcnt(0)
    v_and_b32 v76, v54, v8
    v_and_b32 v77, v54, v9
    v_and_b32 v78, v54, v10
    v_and_b32 v79, v54, v11
    v_and_b32 v80, v55, v8
    v_and_b32 v81, v55, v9
    v_and_b32 v82, v55, v10
    v_and_b32 v83, v55, v11
    v_mfma_f32_16x16x32_bf16 v[24:27], v[76:79], v[120:123], 0
    v_and_b32 v84, v56, v8
    v_and_b32 v85, v56, v9
    v_and_b32 v86, v56, v10
    v_and_b32 v87, v56, v11
    v_mfma_f32_16x16x32_bf16 v[24:27], v[80:83], v[124:127], v[24:27]
    v_and_b32 v88, v57, v8
    v_and_b32 v89, v57, v9
    v_and_b32 v90, v57, v10
    v_and_b32 v91, v57, v11
    v_mfma_f32_16x16x32_bf16 v[24:27], v[84:87], v[128:131], v[24:27]
    v_and_b32 v92, v58, v8
    v_and_b32 v93, v58, v9
    v_and_b32 v94, v58, v10
    v_and_b32 v95, v58, v11
    v_mfma_f32_16x16x32_bf16 v[24:27], v[88:91], v[132:135], v[24:27]
    v_and_b32 v96, v59, v8
    v_and_b32 v97, v59, v9
    v_and_b32 v98, v59, v10
    v_and_b32 v99, v59, v11
    s_waitcnt vmcnt(4)
    buffer_load_dwordx4 v[156:159], v13, s[16:19], s48 offen nt
    s_add_u32 s48, s48, 262144
    s_cmp_ge_u32 s48, s54
    s_cselect_b32 s4, 2883584, 0
    s_sub_u32 s48, s48, s4
    v_mfma_f32_16x16x32_bf16 v[24:27], v[92:95], v[136:139], v[24:27]
    v_and_b32 v100, v60, v8
    v_and_b32 v101, v60, v9
    v_and_b32 v102, v60, v10
    v_and_b32 v103, v60, v11
    s_waitcnt vmcnt(4)
    buffer_load_dwordx4 v[160:163], v13, s[16:19], s48 offen nt
    s_add_u32 s48, s48, 262144
    v_mfma_f32_16x16x32_bf16 v[24:27], v[96:99], v[140:143], v[24:27]
    v_and_b32 v104, v61, v8
    v_and_b32 v105, v61, v9
    v_and_b32 v106, v61, v10
    v_and_b32 v107, v61, v11
    s_waitcnt vmcnt(4)
    v_mfma_f32_16x16x32_bf16 v[24:27], v[100:103], v[144:147], v[24:27]
    v_and_b32 v108, v62, v8
    v_and_b32 v109, v62, v9
    v_and_b32 v110, v62, v10
    v_and_b32 v111, v62, v11
    s_waitcnt vmcnt(3)
    v_mfma_f32_16x16x32_bf16 v[24:27], v[104:107], v[148:151], v[24:27]
    v_and_b32 v112, v63, v8
    v_and_b32 v113, v63, v9
    v_and_b32 v114, v63, v10
    v_and_b32 v115, v63, v11
    s_waitcnt vmcnt(2)
    buffer_load_dwordx4 v[164:167], v14, s[20:23], s49 offen nt
    s_add_u32 s49, s49, 229376
    s_cmp_ge_u32 s49, s55
    s_cselect_b32 s4, 2523136, 0
    s_sub_u32 s49, s49, s4
    v_mfma_f32_16x16x32_bf16 v[24:27], v[108:111], v[152:155], v[24:27]
    v_and_b32 v116, v64, v8
    v_and_b32 v117, v64, v9
    v_and_b32 v118, v64, v10
    v_and_b32 v119, v64, v11
    s_waitcnt vmcnt(2)
    buffer_load_dwordx4 v[168:171], v14, s[20:23], s49 offen nt
    s_add_u32 s49, s49, 229376
    s_cmp_ge_u32 s49, s55
    s_cselect_b32 s4, 2523136, 0
    s_sub_u32 s49, s49, s4
    v_mfma_f32_16x16x32_bf16 v[24:27], v[112:115], v[156:159], v[24:27]
    s_waitcnt vmcnt(2)
    buffer_load_dwordx4 v[172:175], v14, s[20:23], s49 offen nt
    s_add_u32 s49, s49, 229376
    s_cmp_ge_u32 s49, s55
    s_cselect_b32 s4, 2523136, 0
    s_sub_u32 s49, s49, s4
    v_mfma_f32_16x16x32_bf16 v[24:27], v[116:119], v[160:163], v[24:27]
    v_mov_b32 v52, 1
    s_nop 6
    ds_write_b128 v18, v[24:27] offset:0
    s_waitcnt lgkmcnt(0)
    s_barrier
    s_cmp_ge_u32 s97, 56
    s_cbranch_scc1 L_P2
    s_waitcnt vmcnt(2)
    buffer_load_dwordx4 v[176:179], v14, s[20:23], s49 offen nt
    s_add_u32 s49, s49, 229376
    s_cmp_ge_u32 s49, s55
    s_cselect_b32 s4, 2523136, 0
    s_sub_u32 s49, s49, s4
    buffer_load_dwordx4 v[180:183], v14, s[20:23], s49 offen nt
    s_add_u32 s49, s49, 229376
    s_cmp_ge_u32 s49, s55
    s_cselect_b32 s4, 2523136, 0
    s_sub_u32 s49, s49, s4
    v_mfma_f32_16x16x32_bf16 v[28:31], v[76:79], v[164:167], 0
    s_waitcnt vmcnt(3)
    buffer_load_dwordx4 v[184:187], v14, s[20:23], s49 offen nt
    s_add_u32 s49, s49, 229376
    s_cmp_ge_u32 s49, s55
    s_cselect_b32 s4, 2523136, 0
    s_sub_u32 s49, s49, s4
    v_mfma_f32_16x16x32_bf16 v[28:31], v[80:83], v[168:171], v[28:31]
    s_waitcnt vmcnt(3)
    buffer_load_dwordx4 v[188:191], v14, s[20:23], s49 offen nt
    s_add_u32 s49, s49, 229376
    s_cmp_ge_u32 s49, s55
    s_cselect_b32 s4, 2523136, 0
    s_sub_u32 s49, s49, s4
    v_mfma_f32_16x16x32_bf16 v[28:31], v[84:87], v[172:175], v[28:31]
    s_waitcnt vmcnt(3)
    buffer_load_dwordx4 v[192:195], v14, s[20:23], s49 offen nt
    s_add_u32 s49, s49, 229376
    s_cmp_ge_u32 s49, s55
    s_cselect_b32 s4, 2523136, 0
    s_sub_u32 s49, s49, s4
    v_mfma_f32_16x16x32_bf16 v[28:31], v[88:91], v[176:179], v[28:31]
    s_waitcnt vmcnt(3)
    buffer_load_dwordx4 v[196:199], v14, s[20:23], s49 offen nt
    s_add_u32 s49, s49, 229376
    s_cmp_ge_u32 s49, s55
    s_cselect_b32 s4, 2523136, 0
    s_sub_u32 s49, s49, s4
    v_mfma_f32_16x16x32_bf16 v[28:31], v[92:95], v[180:183], v[28:31]
    s_waitcnt vmcnt(3)
    buffer_load_dwordx4 v[200:203], v14, s[20:23], s49 offen nt
    s_add_u32 s49, s49, 229376
    s_cmp_ge_u32 s49, s55
    s_cselect_b32 s4, 2523136, 0
    s_sub_u32 s49, s49, s4
    v_mfma_f32_16x16x32_bf16 v[28:31], v[96:99], v[184:187], v[28:31]
    s_waitcnt vmcnt(3)
    buffer_load_dwordx4 v[204:207], v14, s[20:23], s49 offen nt
    s_add_u32 s49, s49, 229376
    buffer_load_dwordx4 v[208:211], v14, s[24:27], s50 offen nt
    s_add_u32 s50, s50, 229376
    s_cmp_ge_u32 s50, s59
    s_cselect_b32 s4, 2523136, 0
    s_sub_u32 s50, s50, s4
    buffer_load_dwordx4 v[212:215], v14, s[24:27], s50 offen nt
    s_add_u32 s50, s50, 229376
    s_cmp_ge_u32 s50, s59
    s_cselect_b32 s4, 2523136, 0
    s_sub_u32 s50, s50, s4
    v_mfma_f32_16x16x32_bf16 v[28:31], v[100:103], v[188:191], v[28:31]
    s_waitcnt vmcnt(5)
    buffer_load_dwordx4 v[216:219], v14, s[24:27], s50 offen nt
    s_add_u32 s50, s50, 229376
    s_cmp_ge_u32 s50, s59
    s_cselect_b32 s4, 2523136, 0
    s_sub_u32 s50, s50, s4
    v_mfma_f32_16x16x32_bf16 v[28:31], v[104:107], v[192:195], v[28:31]
    s_waitcnt vmcnt(5)
    buffer_load_dwordx4 v[220:223], v14, s[24:27], s50 offen nt
    s_add_u32 s50, s50, 229376
    s_cmp_ge_u32 s50, s59
    s_cselect_b32 s4, 2523136, 0
    s_sub_u32 s50, s50, s4
    v_mfma_f32_16x16x32_bf16 v[28:31], v[108:111], v[196:199], v[28:31]
    s_waitcnt vmcnt(5)
    buffer_load_dwordx4 v[224:227], v14, s[24:27], s50 offen nt
    s_add_u32 s50, s50, 229376
    s_cmp_ge_u32 s50, s59
    s_cselect_b32 s4, 2523136, 0
    s_sub_u32 s50, s50, s4
    v_mfma_f32_16x16x32_bf16 v[28:31], v[112:115], v[200:203], v[28:31]
    s_waitcnt vmcnt(5)
    buffer_load_dwordx4 v[228:231], v14, s[24:27], s50 offen nt
    s_add_u32 s50, s50, 229376
    s_cmp_ge_u32 s50, s59
    s_cselect_b32 s4, 2523136, 0
    s_sub_u32 s50, s50, s4
    v_mfma_f32_16x16x32_bf16 v[28:31], v[116:119], v[204:207], v[28:31]
    s_waitcnt vmcnt(5)
    buffer_load_dwordx4 v[232:235], v14, s[24:27], s50 offen nt
    s_add_u32 s50, s50, 229376
    s_cmp_ge_u32 s50, s59
    s_cselect_b32 s4, 2523136, 0
    s_sub_u32 s50, s50, s4
    buffer_load_dwordx4 v[236:239], v14, s[24:27], s50 offen nt
    s_add_u32 s50, s50, 229376
    s_cmp_ge_u32 s50, s59
    s_cselect_b32 s4, 2523136, 0
    s_sub_u32 s50, s50, s4
    v_mfma_f32_16x16x32_bf16 v[32:35], v[76:79], v[208:211], 0
    s_waitcnt vmcnt(6)
    buffer_load_dwordx4 v[240:243], v14, s[24:27], s50 offen nt
    s_add_u32 s50, s50, 229376
    s_cmp_ge_u32 s50, s59
    s_cselect_b32 s4, 2523136, 0
    s_sub_u32 s50, s50, s4
    v_mfma_f32_16x16x32_bf16 v[32:35], v[80:83], v[212:215], v[32:35]
    s_waitcnt vmcnt(6)
    buffer_load_dwordx4 v[244:247], v14, s[24:27], s50 offen nt
    s_add_u32 s50, s50, 229376
    s_cmp_ge_u32 s50, s59
    s_cselect_b32 s4, 2523136, 0
    s_sub_u32 s50, s50, s4
    v_mfma_f32_16x16x32_bf16 v[32:35], v[84:87], v[216:219], v[32:35]
    s_waitcnt vmcnt(6)
    buffer_load_dwordx4 v[248:251], v14, s[24:27], s50 offen nt
    s_add_u32 s50, s50, 229376
    v_mfma_f32_16x16x32_bf16 v[32:35], v[88:91], v[220:223], v[32:35]
    ds_write_b128 v18, v[28:31] offset:2048
    s_waitcnt vmcnt(6)
    v_mfma_f32_16x16x32_bf16 v[32:35], v[92:95], v[224:227], v[32:35]
    s_waitcnt vmcnt(5)
    v_mfma_f32_16x16x32_bf16 v[32:35], v[96:99], v[228:231], v[32:35]
    s_waitcnt vmcnt(4)
    buffer_load_dwordx4 v[120:123], v15, s[28:31], s51 offen nt
    s_add_u32 s51, s51, 32768
    v_mfma_f32_16x16x32_bf16 v[32:35], v[100:103], v[232:235], v[32:35]
    s_waitcnt vmcnt(4)
    buffer_load_dwordx4 v[124:127], v15, s[28:31], s51 offen nt
    s_add_u32 s51, s51, 32768
    v_mfma_f32_16x16x32_bf16 v[32:35], v[104:107], v[236:239], v[32:35]
    s_waitcnt vmcnt(4)
    buffer_load_dwordx4 v[128:131], v15, s[28:31], s51 offen nt
    s_add_u32 s51, s51, 32768
    v_mfma_f32_16x16x32_bf16 v[32:35], v[108:111], v[240:243], v[32:35]
    s_waitcnt vmcnt(4)
    buffer_load_dwordx4 v[132:135], v15, s[28:31], s51 offen nt
    s_add_u32 s51, s51, 32768
    v_mfma_f32_16x16x32_bf16 v[32:35], v[112:115], v[244:247], v[32:35]
    s_waitcnt vmcnt(4)
    buffer_load_dwordx4 v[136:139], v15, s[28:31], s51 offen nt
    s_add_u32 s51, s51, 32768
    v_mfma_f32_16x16x32_bf16 v[32:35], v[116:119], v[248:251], v[32:35]
    s_nop 7
    ds_write_b128 v18, v[32:35] offset:4096
    s_waitcnt lgkmcnt(0)
    s_barrier
    v_mov_b32 v52, 1
    s_waitcnt vmcnt(4)
    buffer_load_dwordx4 v[140:143], v15, s[28:31], s51 offen nt
    s_add_u32 s51, s51, 32768
    s_waitcnt vmcnt(4)
    buffer_load_dwordx4 v[144:147], v15, s[28:31], s51 offen nt
    s_add_u32 s51, s51, 32768
    s_waitcnt vmcnt(4)
    buffer_load_dwordx4 v[148:151], v15, s[28:31], s51 offen nt
    s_add_u32 s51, s51, 32768
    s_waitcnt vmcnt(3)
    buffer_load_dwordx4 v[164:167], v15, s[32:35], s52 offen nt
    s_add_u32 s52, s52, 32768
    s_waitcnt vmcnt(3)
    buffer_load_dwordx4 v[168:171], v15, s[32:35], s52 offen nt
    s_add_u32 s52, s52, 32768
    s_waitcnt vmcnt(3)
    buffer_load_dwordx4 v[172:175], v15, s[32:35], s52 offen nt
    s_add_u32 s52, s52, 32768
    ds_write_b32 v22, v52 offset:16
    s_waitcnt vmcnt(3)
    buffer_load_dwordx4 v[176:179], v15, s[32:35], s52 offen nt
    s_add_u32 s52, s52, 32768
    s_waitcnt vmcnt(3)
    buffer_load_dwordx4 v[180:183], v15, s[32:35], s52 offen nt
    s_add_u32 s52, s52, 32768
    ds_write_b32 v22, v52 offset:20
    s_waitcnt vmcnt(3)
    buffer_load_dwordx4 v[184:187], v15, s[32:35], s52 offen nt
    s_add_u32 s52, s52, 32768
    s_waitcnt vmcnt(3)
    buffer_load_dwordx4 v[188:191], v15, s[32:35], s52 offen nt
    s_add_u32 s52, s52, 32768
    s_mov_b32 s58, 0
L_sp1:
    ds_read_b64 v[52:53], v22
    ds_read2_b32 v[44:45], v20 offset0:0 offset1:16
    ds_read2_b32 v[46:47], v20 offset0:32 offset1:48
    ds_read2_b32 v[48:49], v20 offset0:64 offset1:80
    ds_read2_b32 v[50:51], v20 offset0:96 offset1:112
    s_add_u32 s58, s58, 1
    s_cmp_gt_u32 s58, 4194304
    s_waitcnt lgkmcnt(0)
    s_cbranch_scc1 L_spd2
    v_and_b32 v52, v52, v53
    v_cmp_eq_u32 vcc, 0, v52
    s_cbranch_vccnz L_sp1
L_spd2:
    v_and_b32 v76, v44, v8
    v_and_b32 v77, v44, v9
    v_and_b32 v78, v44, v10
    v_and_b32 v79, v44, v11
    v_and_b32 v80, v45, v8
    v_and_b32 v81, v45, v9
    v_and_b32 v82, v45, v10
    v_and_b32 v83, v45, v11
    v_mfma_f32_16x16x32_bf16 v[36:39], v[76:79], v[120:123], 0
    v_and_b32 v84, v46, v8
    v_and_b32 v85, v46, v9
    v_and_b32 v86, v46, v10
    v_and_b32 v87, v46, v11
    v_mfma_f32_16x16x32_bf16 v[36:39], v[80:83], v[124:127], v[36:39]
    v_and_b32 v88, v47, v8
    v_and_b32 v89, v47, v9
    v_and_b32 v90, v47, v10
    v_and_b32 v91, v47, v11
    v_mfma_f32_16x16x32_bf16 v[36:39], v[84:87], v[128:131], v[36:39]
    v_and_b32 v92, v48, v8
    v_and_b32 v93, v48, v9
    v_and_b32 v94, v48, v10
    v_and_b32 v95, v48, v11
    v_mfma_f32_16x16x32_bf16 v[36:39], v[88:91], v[132:135], v[36:39]
    v_and_b32 v96, v49, v8
    v_and_b32 v97, v49, v9
    v_and_b32 v98, v49, v10
    v_and_b32 v99, v49, v11
    v_mfma_f32_16x16x32_bf16 v[36:39], v[92:95], v[136:139], v[36:39]
    v_and_b32 v100, v50, v8
    v_and_b32 v101, v50, v9
    v_and_b32 v102, v50, v10
    v_and_b32 v103, v50, v11
    v_mfma_f32_16x16x32_bf16 v[36:39], v[96:99], v[140:143], v[36:39]
    v_and_b32 v104, v51, v8
    v_and_b32 v105, v51, v9
    v_and_b32 v106, v51, v10
    v_and_b32 v107, v51, v11
    v_mfma_f32_16x16x32_bf16 v[36:39], v[100:103], v[144:147], v[36:39]
    s_nop 0
    v_mfma_f32_16x16x32_bf16 v[36:39], v[104:107], v[148:151], v[36:39]
    s_barrier
    ds_read2_b32 v[44:45], v20 offset0:128 offset1:144
    ds_read2_b32 v[46:47], v20 offset0:160 offset1:176
    ds_read2_b32 v[48:49], v20 offset0:192 offset1:208
    ds_read_b32 v50, v20 offset:896
    s_waitcnt lgkmcnt(3)
    v_and_b32 v76, v44, v8
    v_and_b32 v77, v44, v9
    v_and_b32 v78, v44, v10
    v_and_b32 v79, v44, v11
    v_and_b32 v80, v45, v8
    v_and_b32 v81, v45, v9
    v_and_b32 v82, v45, v10
    v_and_b32 v83, v45, v11
    v_mfma_f32_16x16x32_bf16 v[36:39], v[76:79], v[164:167], v[36:39]
    s_waitcnt lgkmcnt(2)
    v_and_b32 v84, v46, v8
    v_and_b32 v85, v46, v9
    v_and_b32 v86, v46, v10
    v_and_b32 v87, v46, v11
    v_mfma_f32_16x16x32_bf16 v[36:39], v[80:83], v[168:171], v[36:39]
    v_and_b32 v88, v47, v8
    v_and_b32 v89, v47, v9
    v_and_b32 v90, v47, v10
    v_and_b32 v91, v47, v11
    v_mfma_f32_16x16x32_bf16 v[36:39], v[84:87], v[172:175], v[36:39]
    s_waitcnt lgkmcnt(1)
    v_and_b32 v92, v48, v8
    v_and_b32 v93, v48, v9
    v_and_b32 v94, v48, v10
    v_and_b32 v95, v48, v11
    s_waitcnt vmcnt(3)
    v_mfma_f32_16x16x32_bf16 v[36:39], v[88:91], v[176:179], v[36:39]
    v_and_b32 v96, v49, v8
    v_and_b32 v97, v49, v9
    v_and_b32 v98, v49, v10
    v_and_b32 v99, v49, v11
    s_waitcnt vmcnt(2)
    v_mfma_f32_16x16x32_bf16 v[36:39], v[92:95], v[180:183], v[36:39]
    s_waitcnt lgkmcnt(0)
    v_and_b32 v100, v50, v8
    v_and_b32 v101, v50, v9
    v_and_b32 v102, v50, v10
    v_and_b32 v103, v50, v11
    s_waitcnt vmcnt(1)
    v_mfma_f32_16x16x32_bf16 v[36:39], v[96:99], v[184:187], v[36:39]
    s_waitcnt vmcnt(0)
    v_mfma_f32_16x16x32_bf16 v[36:39], v[100:103], v[188:191], v[36:39]
    s_nop 7
    ds_write_b128 v17, v[36:39] offset:2048
    s_waitcnt lgkmcnt(0)
    s_barrier
    s_branch L_fin
L_P2:
    s_and_b32 s5, s2, 7
    s_lshl_b32 s6, s96, 2
    s_add_u32 s6, s6, s3
    s_lshl_b32 s54, s5, 8
    s_lshl_b32 s4, s6, 5
    s_add_u32 s54, s54, s4
    s_lshl_b32 s55, s5, 9
    s_add_u32 s55, s55, 589824
    s_lshl_b32 s5, s5, 14
    s_lshl_b32 s6, s6, 6
    s_add_u32 s5, s5, s6
    s_add_u32 s48, s5, 1048576
    s_add_u32 s49, s48, 8192
    s_add_u32 s50, s48, 131072
    s_add_u32 s53, s50, 8192
    v_lshrrev_b32 v4, 2, v1
    v_and_b32 v5, 3, v0
    v_lshlrev_b32 v14, 3, v5
    v_lshlrev_b32 v5, 4, v5
    v_lshl_add_u32 v13, v4, 9, v5
    s_cmp_gt_u32 s96, 1
    s_cbranch_scc1 L_nopd3
    v_add_u32 v4, 524288, v13
    buffer_load_dword v32, v4, s[12:15], s50 offen sc1
    buffer_load_dword v32, v4, s[12:15], s53 offen sc1
L_nopd3:
    s_barrier
    v_mov_b32 v52, 1
    s_waitcnt vmcnt(2)
    buffer_load_dwordx4 v[120:123], v15, s[28:31], s51 offen nt
    s_add_u32 s51, s51, 32768
    s_waitcnt vmcnt(2)
    buffer_load_dwordx4 v[124:127], v15, s[28:31], s51 offen nt
    s_add_u32 s51, s51, 32768
    s_waitcnt vmcnt(2)
    buffer_load_dwordx4 v[128:131], v15, s[28:31], s51 offen nt
    s_add_u32 s51, s51, 32768
    s_waitcnt vmcnt(2)
    buffer_load_dwordx4 v[132:135], v15, s[28:31], s51 offen nt
    s_add_u32 s51, s51, 32768
    s_waitcnt vmcnt(2)
    buffer_load_dwordx4 v[136:139], v15, s[28:31], s51 offen nt
    s_add_u32 s51, s51, 32768
    s_waitcnt vmcnt(2)
    buffer_load_dwordx4 v[140:143], v15, s[28:31], s51 offen nt
    s_add_u32 s51, s51, 32768
    s_waitcnt vmcnt(2)
    buffer_load_dwordx4 v[144:147], v15, s[28:31], s51 offen nt
    s_add_u32 s51, s51, 32768
    s_waitcnt vmcnt(2)
    buffer_load_dwordx4 v[148:151], v15, s[28:31], s51 offen nt
    s_add_u32 s51, s51, 32768
    s_waitcnt vmcnt(2)
    buffer_load_dwordx4 v[152:155], v15, s[32:35], s52 offen nt
    s_add_u32 s52, s52, 32768
    s_waitcnt vmcnt(2)
    buffer_load_dwordx4 v[156:159], v15, s[32:35], s52 offen nt
    s_add_u32 s52, s52, 32768
    s_waitcnt vmcnt(2)
    buffer_load_dwordx4 v[160:163], v15, s[32:35], s52 offen nt
    s_add_u32 s52, s52, 32768
    s_waitcnt vmcnt(2)
    buffer_load_dwordx4 v[164:167], v15, s[32:35], s52 offen nt
    s_add_u32 s52, s52, 32768
    s_waitcnt vmcnt(2)
    buffer_load_dwordx4 v[168:171], v15, s[32:35], s52 offen nt
    s_add_u32 s52, s52, 32768
    s_waitcnt vmcnt(2)
    buffer_load_dwordx4 v[172:175], v15, s[32:35], s52 offen nt
    s_add_u32 s52, s52, 32768
    s_waitcnt vmcnt(2)
    buffer_load_dwordx4 v[176:179], v15, s[32:35], s52 offen nt
    s_add_u32 s52, s52, 32768
    ds_write_b32 v22, v52 offset:16
    ds_write_b32 v22, v52 offset:20
    s_mov_b32 s58, 0
L_sp4:
    ds_read_b64 v[52:53], v22
    ds_read2_b32 v[44:45], v20 offset0:0 offset1:16
    ds_read2_b32 v[46:47], v20 offset0:32 offset1:48
    ds_read2_b32 v[48:49], v20 offset0:64 offset1:80
    ds_read2_b32 v[50:51], v20 offset0:96 offset1:112
    s_add_u32 s58, s58, 1
    s_cmp_gt_u32 s58, 4194304
    s_waitcnt lgkmcnt(0)
    s_cbranch_scc1 L_spd5
    v_and_b32 v52, v52, v53
    v_cmp_eq_u32 vcc, 0, v52
    s_cbranch_vccnz L_sp4
L_spd5:
    v_and_b32 v4, 31, v0
    v_lshlrev_b32 v19, 4, v4
    buffer_load_dwordx4 v[28:31], v19, s[12:15], s55 offen sc1
    v_and_b32 v76, v44, v8
    v_and_b32 v77, v44, v9
    v_and_b32 v78, v44, v10
    v_and_b32 v79, v44, v11
    v_and_b32 v80, v45, v8
    v_and_b32 v81, v45, v9
    v_and_b32 v82, v45, v10
    v_and_b32 v83, v45, v11
    v_mfma_f32_16x16x32_bf16 v[36:39], v[76:79], v[120:123], 0
    v_and_b32 v84, v46, v8
    v_and_b32 v85, v46, v9
    v_and_b32 v86, v46, v10
    v_and_b32 v87, v46, v11
    v_mfma_f32_16x16x32_bf16 v[36:39], v[80:83], v[124:127], v[36:39]
    v_and_b32 v88, v47, v8
    v_and_b32 v89, v47, v9
    v_and_b32 v90, v47, v10
    v_and_b32 v91, v47, v11
    v_mfma_f32_16x16x32_bf16 v[36:39], v[84:87], v[128:131], v[36:39]
    v_and_b32 v92, v48, v8
    v_and_b32 v93, v48, v9
    v_and_b32 v94, v48, v10
    v_and_b32 v95, v48, v11
    v_mfma_f32_16x16x32_bf16 v[36:39], v[88:91], v[132:135], v[36:39]
    v_and_b32 v96, v49, v8
    v_and_b32 v97, v49, v9
    v_and_b32 v98, v49, v10
    v_and_b32 v99, v49, v11
    v_mfma_f32_16x16x32_bf16 v[36:39], v[92:95], v[136:139], v[36:39]
    v_and_b32 v100, v50, v8
    v_and_b32 v101, v50, v9
    v_and_b32 v102, v50, v10
    v_and_b32 v103, v50, v11
    v_mfma_f32_16x16x32_bf16 v[36:39], v[96:99], v[140:143], v[36:39]
    v_and_b32 v104, v51, v8
    v_and_b32 v105, v51, v9
    v_and_b32 v106, v51, v10
    v_and_b32 v107, v51, v11
    v_mfma_f32_16x16x32_bf16 v[36:39], v[100:103], v[144:147], v[36:39]
    s_nop 0
    v_mfma_f32_16x16x32_bf16 v[36:39], v[104:107], v[148:151], v[36:39]
    s_barrier
    ds_read2_b32 v[44:45], v20 offset0:128 offset1:144
    ds_read2_b32 v[46:47], v20 offset0:160 offset1:176
    ds_read2_b32 v[48:49], v20 offset0:192 offset1:208
    ds_read_b32 v50, v20 offset:896
    s_waitcnt lgkmcnt(3)
    v_and_b32 v76, v44, v8
    v_and_b32 v77, v44, v9
    v_and_b32 v78, v44, v10
    v_and_b32 v79, v44, v11
    v_and_b32 v80, v45, v8
    v_and_b32 v81, v45, v9
    v_and_b32 v82, v45, v10
    v_and_b32 v83, v45, v11
    v_mfma_f32_16x16x32_bf16 v[36:39], v[76:79], v[152:155], v[36:39]
    s_waitcnt lgkmcnt(2)
    v_and_b32 v84, v46, v8
    v_and_b32 v85, v46, v9
    v_and_b32 v86, v46, v10
    v_and_b32 v87, v46, v11
    v_mfma_f32_16x16x32_bf16 v[36:39], v[80:83], v[156:159], v[36:39]
    v_and_b32 v88, v47, v8
    v_and_b32 v89, v47, v9
    v_and_b32 v90, v47, v10
    v_and_b32 v91, v47, v11
    v_mfma_f32_16x16x32_bf16 v[36:39], v[84:87], v[160:163], v[36:39]
    s_waitcnt lgkmcnt(1)
    v_and_b32 v92, v48, v8
    v_and_b32 v93, v48, v9
    v_and_b32 v94, v48, v10
    v_and_b32 v95, v48, v11
    v_mfma_f32_16x16x32_bf16 v[36:39], v[88:91], v[164:167], v[36:39]
    v_and_b32 v96, v49, v8
    v_and_b32 v97, v49, v9
    v_and_b32 v98, v49, v10
    v_and_b32 v99, v49, v11
    s_waitcnt vmcnt(3)
    v_mfma_f32_16x16x32_bf16 v[36:39], v[92:95], v[168:171], v[36:39]
    s_waitcnt lgkmcnt(0)
    v_and_b32 v100, v50, v8
    v_and_b32 v101, v50, v9
    v_and_b32 v102, v50, v10
    v_and_b32 v103, v50, v11
    s_waitcnt vmcnt(2)
    v_mfma_f32_16x16x32_bf16 v[36:39], v[96:99], v[172:175], v[36:39]
    s_waitcnt vmcnt(1)
    v_mfma_f32_16x16x32_bf16 v[36:39], v[100:103], v[176:179], v[36:39]
    s_nop 7
    ds_write_b128 v17, v[36:39] offset:2048
    s_waitcnt lgkmcnt(0)
    s_barrier
    s_cmp_gt_u32 s96, 1
    s_cbranch_scc1 L_fin
    s_waitcnt vmcnt(0)
    s_mov_b32 s58, 0
    v_xor_b32 v28, s40, v28
    v_xor_b32 v29, s41, v29
    v_xor_b32 v30, s42, v30
    v_xor_b32 v31, s43, v31
    v_or3_b32 v4, v28, v29, v30
    v_or3_b32 v4, v4, v31, v31
    v_cmp_ne_u32_sdwa vcc, v4, 0 src0_sel:BYTE_0 src1_sel:DWORD
    s_cbranch_vccz L_ok8
L_retry6:
    s_mov_b64 exec, vcc
    buffer_load_dwordx4 v[28:31], v19, s[12:15], s55 offen sc1
    s_add_u32 s58, s58, 1
    s_cmp_gt_u32 s58, 262144
    s_waitcnt vmcnt(0)
    s_cbranch_scc1 L_rex7
    v_xor_b32 v28, s40, v28
    v_xor_b32 v29, s41, v29
    v_xor_b32 v30, s42, v30
    v_xor_b32 v31, s43, v31
    v_or3_b32 v4, v28, v29, v30
    v_or3_b32 v4, v4, v31, v31
    v_cmp_ne_u32_sdwa vcc, v4, 0 src0_sel:BYTE_0 src1_sel:DWORD
    s_cbranch_vccnz L_retry6
L_rex7:
    s_mov_b64 exec, -1
L_ok8:
    s_getreg_b32 s5, hwreg(HW_REG_XCC_ID, 0, 4)
    s_lshl_b32 s5, s5, 8
    v_cmp_ne_u32 vcc, s5, v28
    s_cmp_eq_u64 vcc, 0
    s_cselect_b32 s4, 524288, 0
    s_add_u32 s48, s48, s4
    s_add_u32 s49, s49, s4
    s_add_u32 s50, s50, s4
    s_add_u32 s53, s53, s4
    v_lshl_add_u32 v7, v3, 1, v14
    buffer_load_ushort v24, v7, s[8:11], s54 offen
    buffer_load_dwordx4 v[216:219], v13, s[12:15], s50 offen sc1
    buffer_load_dwordx4 v[220:223], v13, s[12:15], s53 offen sc1
    s_waitcnt vmcnt(0)
    v_lshlrev_b32 v24, 16, v24
    s_mov_b32 s58, 0
    v_xor_b32 v216, s40, v216
    v_xor_b32 v217, s41, v217
    v_xor_b32 v218, s42, v218
    v_xor_b32 v219, s43, v219
    v_xor_b32 v220, s40, v220
    v_xor_b32 v221, s41, v221
    v_xor_b32 v222, s42, v222
    v_xor_b32 v223, s43, v223
    v_or3_b32 v4, v216, v217, v218
    v_or3_b32 v5, v219, v220, v221
    v_or3_b32 v4, v4, v222, v223
    v_or_b32 v4, v4, v5
    v_cmp_ne_u32_sdwa vcc, v4, 0 src0_sel:BYTE_0 src1_sel:DWORD
    s_cbranch_vccz L_ok11
L_retry9:
    s_mov_b64 exec, vcc
    buffer_load_dwordx4 v[216:219], v13, s[12:15], s50 offen sc1
    buffer_load_dwordx4 v[220:223], v13, s[12:15], s53 offen sc1
    s_add_u32 s58, s58, 1
    s_cmp_gt_u32 s58, 262144
    s_waitcnt vmcnt(0)
    s_cbranch_scc1 L_rex10
    v_xor_b32 v216, s40, v216
    v_xor_b32 v217, s41, v217
    v_xor_b32 v218, s42, v218
    v_xor_b32 v219, s43, v219
    v_xor_b32 v220, s40, v220
    v_xor_b32 v221, s41, v221
    v_xor_b32 v222, s42, v222
    v_xor_b32 v223, s43, v223
    v_or3_b32 v4, v216, v217, v218
    v_or3_b32 v5, v219, v220, v221
    v_or3_b32 v4, v4, v222, v223
    v_or_b32 v4, v4, v5
    v_cmp_ne_u32_sdwa vcc, v4, 0 src0_sel:BYTE_0 src1_sel:DWORD
    s_cbranch_vccnz L_retry9
L_rex10:
    s_mov_b64 exec, -1
L_ok11:
    v_pk_add_f32 v[216:217], v[216:217], v[220:221]
    v_pk_add_f32 v[218:219], v[218:219], v[222:223]
    s_nop 1
    v_permlane32_swap_b32 v216, v218
    v_permlane32_swap_b32 v217, v219
    v_pk_add_f32 v[4:5], v[216:217], v[218:219]
    s_nop 1
    v_permlane16_swap_b32 v4, v5
    v_add_f32 v4, v4, v5
    s_nop 1
    v_add_f32_dpp v4, v4, v4 row_ror:8 row_mask:0xf bank_mask:0xf
    s_nop 1
    v_add_f32_dpp v4, v4, v4 row_ror:4 row_mask:0xf bank_mask:0xf
    v_add_f32 v4, v24, v4
    s_mov_b32 exec_lo, 0xf000f
    s_mov_b32 exec_hi, 0xf000f
    v_cvt_pk_bf16_f32 v4, v4, v4
    buffer_store_short v4, v7, s[36:39], s54 offen nt
    s_branch L_fin
L_AS1:
    s_load_dwordx2 s[20:21], s[0:1], s57
    s_load_dwordx2 s[24:25], s[0:1], 56
    s_load_dwordx2 s[28:29], s[0:1], 32
    s_load_dwordx2 s[32:33], s[0:1], 64
    s_load_dwordx2 s[36:37], s[0:1], 72
    s_load_dword s56, s[12:13], 0
    s_mov_b32 s14, 0x200000
    s_mov_b32 s15, 0x20000
    s_mov_b32 s22, 0x4000000
    s_mov_b32 s23, 0x20000
    s_mov_b32 s30, 0x800000
    s_mov_b32 s31, 0x20000
    s_mov_b32 s34, 0x700000
    s_mov_b32 s35, 0x20000
    s_mov_b32 s44, 0x7060500
    s_mov_b32 s45, 0x7060501
    s_mov_b32 s46, 0x7060502
    s_mov_b32 s47, 0x7060503
    s_mov_b32 s98, 0x3fb8aa3b
    s_mov_b32 s99, 0xffff0000
    v_lshrrev_b32 v6, 1, v2
    v_and_b32 v7, 1, v0
    v_lshl_add_u32 v7, v7, 4, v4
    v_xor_b32 v5, v3, v6
    v_lshl_add_u32 v28, v5, 5, v7
    v_xor_b32 v29, 128, v28
    v_and_b32 v4, 1, v0
    v_lshlrev_b32 v4, 4, v4
    v_mov_b32 v5, 0xffff
    v_lshlrev_b32 v4, v4, v5
    v_bfe_u32 v5, v0, 1, 2
    v_cmp_eq_u32 vcc, 0, v5
    s_nop 1
    v_cndmask_b32 v8, 0, v4, vcc
    v_cmp_eq_u32 vcc, 1, v5
    s_nop 1
    v_cndmask_b32 v9, 0, v4, vcc
    v_cmp_eq_u32 vcc, 2, v5
    s_nop 1
    v_cndmask_b32 v10, 0, v4, vcc
    v_cmp_eq_u32 vcc, 3, v5
    s_nop 1
    v_cndmask_b32 v11, 0, v4, vcc
    s_lshr_b32 s4, s2, 3
    s_and_b32 s5, s2, 7
    s_lshl_b32 s7, s5, 8
    s_lshl_b32 s6, s3, 13
    s_add_u32 s7, s7, s6
    s_mul_i32 s6, s4, 7
    s_lshl_b32 s52, s6, 15
    s_add_u32 s52, s52, s7
    s_lshr_b32 s4, s2, 3
    s_and_b32 s5, s2, 7
    s_lshl_b32 s7, s5, 8
    s_lshl_b32 s6, s3, 13
    s_add_u32 s7, s7, s6
    s_lshl_b32 s51, s4, 18
    s_add_u32 s51, s51, s7
    v_lshlrev_b32 v4, 4, v2
    v_lshl_add_u32 v15, v3, 11, v4
    s_lshl_b32 s4, s3, 4
    s_add_u32 s4, s4, 137984
    v_lshl_add_u32 v20, v3, 2, s4
    v_mov_b32 v22, 140544
    v_and_b32 v4, 1, v3
    v_lshlrev_b32 v4, 4, v4
    v_lshl_add_u32 v4, v2, 5, v4
    s_lshl_b32 s4, s3, 9
    s_add_u32 s4, s4, 140608
    v_add_u32 v17, s4, v4
    v_and_b32 v6, 7, v0
    v_mul_u32_u24 v4, 272, v6
    v_lshl_add_u32 v4, v3, 4, v4
    v_add_u32 v19, 131072, v4
    v_xor_b32 v4, v3, v2
    v_lshlrev_b32 v4, 4, v4
    v_lshl_add_u32 v4, v2, 8, v4
    v_xor_b32 v5, 0, v4
    v_add_u32 v32, s50, v5
    v_xor_b32 v5, 64, v4
    v_add_u32 v33, s50, v5
    v_xor_b32 v5, 128, v4
    v_add_u32 v34, s50, v5
    v_xor_b32 v5, 192, v4
    v_add_u32 v35, s50, v5
    v_lshrrev_b32 v4, 2, v1
    v_and_b32 v5, 7, v4
    v_and_b32 v6, 3, v0
    v_lshlrev_b32 v6, 3, v6
    v_lshl_add_u32 v6, v4, 8, v6
    v_add_u32 v6, 65536, v6
    v_and_b32 v6, 7, v0
    v_lshlrev_b32 v4, 5, v6
    v_add_u32 v69, 133376, v4
    s_lshl_b32 s4, s3, 2
    v_add_u32 v68, s4, v69
    s_lshl_b32 s4, s3, 8
    s_add_u32 s4, s4, 140608
    v_lshl_add_u32 v4, v1, 2, s4
    v_cmp_gt_u32 vcc, 8, v1
    s_nop 1
    v_cndmask_b32 v68, v4, v68, vcc
    v_lshlrev_b32 v4, 4, v6
    v_lshl_add_u32 v71, v3, 7, v4
    v_add_u32 v71, 133888, v71
    v_bfe_u32 v7, v0, 3, 1
    v_lshl_add_u32 v70, v7, 3, v71
    s_lshl_b32 s4, s3, 9
    v_add_u32 v70, s4, v70
    s_lshl_b32 s4, s96, 16
    s_lshl_b32 s5, s97, 9
    s_add_u32 s4, s4, s5
    s_lshl_b32 s5, s3, 6
    s_add_u32 s4, s4, s5
    s_add_u32 s54, s4, 262144
    v_lshlrev_b32 v4, 13, v6
    v_lshl_add_u32 v73, v3, 4, v4
    v_lshlrev_b32 v74, 4, v6
    s_lshl_b32 s5, s96, 11
    s_lshl_b32 s6, s97, 7
    s_add_u32 s5, s5, s6
    s_add_u32 s55, s5, 524288
    s_mov_b32 s60, 0xff00ff00
    s_mov_b32 s61, 0xff00ff00
    s_waitcnt lgkmcnt(0)
    s_add_u32 s56, s56, 0x01010101
    v_mov_b32 v12, s56
    s_bfe_u32 s40, s56, 0x80000
    s_bfe_u32 s41, s56, 0x80008
    s_bfe_u32 s42, s56, 0x80010
    s_bfe_u32 s43, s56, 0x80018
    s_waitcnt vmcnt(4)
    s_add_u32 m0, s50, 5120
    s_xor_b32 s49, s48, 40960
    buffer_load_dwordx4 v25, s[16:19], s49 offen nt lds
    s_waitcnt vmcnt(4)
    s_add_u32 m0, s50, 6144
    s_xor_b32 s49, s48, 49152
    buffer_load_dwordx4 v26, s[16:19], s49 offen nt lds
    s_waitcnt vmcnt(4)
    s_add_u32 m0, s50, 7168
    s_xor_b32 s49, s48, 57344
    buffer_load_dwordx4 v27, s[16:19], s49 offen nt lds
    s_waitcnt vmcnt(4)
    s_add_u32 m0, s50, 65536
    s_xor_b32 s49, s48, 0
    buffer_load_dwordx4 v28, s[20:23], s49 offen nt lds
    ds_read_b128 v[184:187], v32 offset:0
    ds_read_b128 v[188:191], v33 offset:0
    ds_read_b128 v[192:195], v34 offset:0
    ds_read_b128 v[196:199], v35 offset:0
    s_waitcnt vmcnt(4)
    s_add_u32 m0, s50, 66560
    s_xor_b32 s49, s48, 8192
    buffer_load_dwordx4 v29, s[20:23], s49 offen nt lds
    s_waitcnt vmcnt(4)
    s_add_u32 m0, s50, 67584
    s_xor_b32 s49, s48, 16384
    buffer_load_dwordx4 v28, s[20:23], s49 offen nt lds
    s_waitcnt vmcnt(4)
    s_add_u32 m0, s50, 68608
    s_xor_b32 s49, s48, 24576
    buffer_load_dwordx4 v29, s[20:23], s49 offen nt lds
    s_waitcnt vmcnt(4)
    s_add_u32 m0, s50, 69632
    s_xor_b32 s49, s48, 32768
    buffer_load_dwordx4 v28, s[20:23], s49 offen nt lds
    ds_read_b128 v[200:203], v32 offset:4096
    ds_read_b128 v[204:207], v33 offset:4096
    ds_read_b128 v[208:211], v34 offset:4096
    ds_read_b128 v[212:215], v35 offset:4096
    s_waitcnt vmcnt(4)
    s_add_u32 m0, s50, 70656
    s_xor_b32 s49, s48, 40960
    buffer_load_dwordx4 v29, s[20:23], s49 offen nt lds
    s_waitcnt vmcnt(4)
    s_add_u32 m0, s50, 71680
    s_xor_b32 s49, s48, 49152
    buffer_load_dwordx4 v28, s[20:23], s49 offen nt lds
    s_waitcnt vmcnt(4)
    s_add_u32 m0, s50, 72704
    s_xor_b32 s49, s48, 57344
    buffer_load_dwordx4 v29, s[20:23], s49 offen nt lds
    s_waitcnt lgkmcnt(0)
    s_barrier
    ds_read_b128 v[88:91], v19 offset:0
    ds_read_b128 v[92:95], v19 offset:64
    ds_read_b128 v[96:99], v19 offset:128
    ds_read_b128 v[100:103], v19 offset:192
    s_mov_b32 s4, 0x3db504f3
    s_mov_b32 s5, 0x3db504f3
    s_waitcnt lgkmcnt(3)
    v_mfma_f32_16x16x32_bf16 v[108:111], v[184:187], v[88:91], 0
    v_mfma_f32_16x16x32_bf16 v[112:115], v[200:203], v[88:91], 0
    s_waitcnt lgkmcnt(2)
    v_mfma_f32_16x16x32_bf16 v[108:111], v[188:191], v[92:95], v[108:111]
    v_mfma_f32_16x16x32_bf16 v[112:115], v[204:207], v[92:95], v[112:115]
    s_waitcnt lgkmcnt(1)
    v_mfma_f32_16x16x32_bf16 v[108:111], v[192:195], v[96:99], v[108:111]
    v_mfma_f32_16x16x32_bf16 v[112:115], v[208:211], v[96:99], v[112:115]
    s_waitcnt lgkmcnt(0)
    v_mfma_f32_16x16x32_bf16 v[108:111], v[196:199], v[100:103], v[108:111]
    v_mfma_f32_16x16x32_bf16 v[112:115], v[212:215], v[100:103], v[112:115]
    buffer_load_dwordx4 v[124:127], v15, s[28:31], s51 offen nt
    s_add_u32 s51, s51, 32768
    buffer_load_dwordx4 v[128:131], v15, s[28:31], s51 offen nt
    s_add_u32 s51, s51, 32768
    s_nop 3
    v_cndmask_b32 v60, v108, v112, s[60:61]
    v_cndmask_b32 v61, v109, v113, s[60:61]
    v_cndmask_b32 v62, v110, v114, s[60:61]
    v_cndmask_b32 v63, v111, v115, s[60:61]
    v_cvt_pk_bf16_f32 v108, v60, v61
    v_cvt_pk_bf16_f32 v109, v62, v63
    v_lshlrev_b32 v60, 16, v108
    v_and_b32 v61, s99, v108
    v_lshlrev_b32 v62, 16, v109
    v_and_b32 v63, s99, v109
    v_pk_mul_f32 v[60:61], v[60:61], s[4:5]
    v_pk_mul_f32 v[62:63], v[62:63], s[4:5]
    v_cvt_pk_bf16_f32 v108, v60, v61
    v_cvt_pk_bf16_f32 v109, v62, v63
    v_lshlrev_b32 v60, 16, v108
    v_and_b32 v61, s99, v108
    v_lshlrev_b32 v62, 16, v109
    v_and_b32 v63, s99, v109
    v_max3_f32 v72, v60, v61, v62
    v_max_f32 v72, v72, v63
    s_nop 1
    v_max_f32_dpp v72, v72, v72 row_ror:8 row_mask:0xf bank_mask:0xf
    v_mov_b32 v5, v72
    s_nop 1
    v_permlane16_swap_b32 v72, v5
    v_max_f32 v72, v72, v5
    v_mov_b32 v5, v72
    s_nop 1
    v_permlane32_swap_b32 v72, v5
    v_max_f32 v72, v72, v5
    ds_write_b32 v68, v72
    s_waitcnt lgkmcnt(0)
    s_barrier
    ds_read_b128 v[108:111], v69
    ds_read_b128 v[112:115], v69 offset:16
    s_waitcnt lgkmcnt(0)
    v_max3_f32 v72, v108, v109, v110
    v_max3_f32 v4, v111, v112, v113
    v_max3_f32 v72, v72, v114, v115
    v_max_f32 v72, v72, v4
    v_mul_f32 v4, s98, v72
    v_fma_f32 v60, v60, s98, -v4
    v_fma_f32 v61, v61, s98, -v4
    v_fma_f32 v62, v62, s98, -v4
    v_fma_f32 v63, v63, s98, -v4
    v_exp_f32 v60, v60
    v_exp_f32 v61, v61
    v_exp_f32 v62, v62
    v_exp_f32 v63, v63
    v_cvt_pk_bf16_f32 v108, v60, v61
    v_cvt_pk_bf16_f32 v109, v62, v63
    ds_write_b64 v70, v[108:109]
    v_add_f32 v60, v60, v61
    v_add_f32 v62, v62, v63
    v_add_f32 v4, v60, v62
    s_nop 1
    v_add_f32_dpp v4, v4, v4 row_ror:8 row_mask:0xf bank_mask:0xf
    v_mov_b32 v5, v4
    s_nop 1
    v_permlane16_swap_b32 v4, v5
    v_add_f32 v4, v4, v5
    v_mov_b32 v5, v4
    s_nop 1
    v_permlane32_swap_b32 v4, v5
    v_add_f32 v4, v4, v5
    ds_write_b32 v68, v4 offset:256
    buffer_load_dwordx4 v[132:135], v15, s[28:31], s51 offen nt
    s_add_u32 s51, s51, 32768
    buffer_load_dwordx4 v[136:139], v15, s[28:31], s51 offen nt
    s_add_u32 s51, s51, 32768
    buffer_load_dwordx4 v[140:143], v15, s[28:31], s51 offen nt
    s_add_u32 s51, s51, 32768
    s_waitcnt vmcnt(5)
    s_waitcnt lgkmcnt(0)
    s_barrier
    s_cmp_lg_u32 s3, 0
    s_cbranch_scc1 L_noml12
    ds_read_b128 v[116:119], v69 offset:256
    ds_read_b128 v[120:123], v69 offset:272
    s_waitcnt lgkmcnt(0)
    v_pk_add_f32 v[116:117], v[116:117], v[118:119]
    v_pk_add_f32 v[120:121], v[120:121], v[122:123]
    v_pk_add_f32 v[116:117], v[116:117], v[120:121]
    v_add_f32 v117, v116, v117
    v_mov_b32 v116, v72
    v_mov_b32 v118, v72
    v_mov_b32 v119, v72
    v_perm_b32 v116, v116, v12, s44
    v_perm_b32 v117, v117, v12, s45
    v_perm_b32 v118, v118, v12, s46
    v_perm_b32 v119, v119, v12, s47
    s_mov_b64 exec, 0xff
    buffer_store_dwordx4 v[116:119], v74, s[12:15], s55 offen sc1
    s_mov_b64 exec, -1
L_noml12:
    v_mov_b32 v52, 1
    s_waitcnt vmcnt(4)
    buffer_load_dwordx4 v[144:147], v15, s[28:31], s51 offen nt
    s_add_u32 s51, s51, 32768
    s_waitcnt vmcnt(4)
    buffer_load_dwordx4 v[148:151], v15, s[28:31], s51 offen nt
    s_add_u32 s51, s51, 32768
    s_waitcnt vmcnt(4)
    buffer_load_dwordx4 v[152:155], v15, s[28:31], s51 offen nt
    s_add_u32 s51, s51, 32768
    s_waitcnt vmcnt(2)
    buffer_load_dwordx4 v[156:159], v15, s[32:35], s52 offen nt
    s_add_u32 s52, s52, 32768
    s_waitcnt vmcnt(2)
    buffer_load_dwordx4 v[160:163], v15, s[32:35], s52 offen nt
    s_add_u32 s52, s52, 32768
    s_waitcnt vmcnt(2)
    buffer_load_dwordx4 v[164:167], v15, s[32:35], s52 offen nt
    s_add_u32 s52, s52, 32768
    ds_write_b32 v22, v52 offset:16
    s_waitcnt vmcnt(2)
    buffer_load_dwordx4 v[168:171], v15, s[32:35], s52 offen nt
    s_add_u32 s52, s52, 32768
    s_waitcnt vmcnt(2)
    buffer_load_dwordx4 v[172:175], v15, s[32:35], s52 offen nt
    s_add_u32 s52, s52, 32768
    s_waitcnt vmcnt(2)
    buffer_load_dwordx4 v[176:179], v15, s[32:35], s52 offen nt
    s_add_u32 s52, s52, 32768
    ds_write_b32 v22, v52 offset:20
    s_waitcnt vmcnt(2)
    buffer_load_dwordx4 v[180:183], v15, s[32:35], s52 offen nt
    s_add_u32 s52, s52, 32768
    s_mov_b32 s58, 0
L_sp13:
    ds_read_b64 v[52:53], v22
    ds_read2_b32 v[44:45], v20 offset0:0 offset1:16
    ds_read2_b32 v[46:47], v20 offset0:32 offset1:48
    ds_read2_b32 v[48:49], v20 offset0:64 offset1:80
    ds_read2_b32 v[50:51], v20 offset0:96 offset1:112
    s_add_u32 s58, s58, 1
    s_cmp_gt_u32 s58, 4194304
    s_waitcnt lgkmcnt(0)
    s_cbranch_scc1 L_spd14
    v_and_b32 v52, v52, v53
    v_cmp_eq_u32 vcc, 0, v52
    s_cbranch_vccnz L_sp13
L_spd14:
    v_and_b32 v76, v44, v8
    v_and_b32 v77, v44, v9
    v_and_b32 v78, v44, v10
    v_and_b32 v79, v44, v11
    v_and_b32 v80, v45, v8
    v_and_b32 v81, v45, v9
    v_and_b32 v82, v45, v10
    v_and_b32 v83, v45, v11
    v_mfma_f32_16x16x32_bf16 v[36:39], v[76:79], v[124:127], 0
    v_and_b32 v84, v46, v8
    v_and_b32 v85, v46, v9
    v_and_b32 v86, v46, v10
    v_and_b32 v87, v46, v11
    v_mfma_f32_16x16x32_bf16 v[36:39], v[80:83], v[128:131], v[36:39]
    v_and_b32 v88, v47, v8
    v_and_b32 v89, v47, v9
    v_and_b32 v90, v47, v10
    v_and_b32 v91, v47, v11
    v_mfma_f32_16x16x32_bf16 v[36:39], v[84:87], v[132:135], v[36:39]
    v_and_b32 v92, v48, v8
    v_and_b32 v93, v48, v9
    v_and_b32 v94, v48, v10
    v_and_b32 v95, v48, v11
    v_mfma_f32_16x16x32_bf16 v[36:39], v[88:91], v[136:139], v[36:39]
    v_and_b32 v96, v49, v8
    v_and_b32 v97, v49, v9
    v_and_b32 v98, v49, v10
    v_and_b32 v99, v49, v11
    v_mfma_f32_16x16x32_bf16 v[36:39], v[92:95], v[140:143], v[36:39]
    v_and_b32 v100, v50, v8
    v_and_b32 v101, v50, v9
    v_and_b32 v102, v50, v10
    v_and_b32 v103, v50, v11
    v_mfma_f32_16x16x32_bf16 v[36:39], v[96:99], v[144:147], v[36:39]
    v_and_b32 v104, v51, v8
    v_and_b32 v105, v51, v9
    v_and_b32 v106, v51, v10
    v_and_b32 v107, v51, v11
    v_mfma_f32_16x16x32_bf16 v[36:39], v[100:103], v[148:151], v[36:39]
    s_nop 0
    v_mfma_f32_16x16x32_bf16 v[36:39], v[104:107], v[152:155], v[36:39]
    s_barrier
    ds_read2_b32 v[44:45], v20 offset0:128 offset1:144
    ds_read2_b32 v[46:47], v20 offset0:160 offset1:176
    ds_read2_b32 v[48:49], v20 offset0:192 offset1:208
    ds_read_b32 v50, v20 offset:896
    s_waitcnt lgkmcnt(3)
    v_and_b32 v76, v44, v8
    v_and_b32 v77, v44, v9
    v_and_b32 v78, v44, v10
    v_and_b32 v79, v44, v11
    v_and_b32 v80, v45, v8
    v_and_b32 v81, v45, v9
    v_and_b32 v82, v45, v10
    v_and_b32 v83, v45, v11
    v_mfma_f32_16x16x32_bf16 v[36:39], v[76:79], v[156:159], v[36:39]
    s_waitcnt lgkmcnt(2)
    v_and_b32 v84, v46, v8
    v_and_b32 v85, v46, v9
    v_and_b32 v86, v46, v10
    v_and_b32 v87, v46, v11
    v_mfma_f32_16x16x32_bf16 v[36:39], v[80:83], v[160:163], v[36:39]
    v_and_b32 v88, v47, v8
    v_and_b32 v89, v47, v9
    v_and_b32 v90, v47, v10
    v_and_b32 v91, v47, v11
    v_mfma_f32_16x16x32_bf16 v[36:39], v[84:87], v[164:167], v[36:39]
    s_waitcnt lgkmcnt(1)
    v_and_b32 v92, v48, v8
    v_and_b32 v93, v48, v9
    v_and_b32 v94, v48, v10
    v_and_b32 v95, v48, v11
    v_mfma_f32_16x16x32_bf16 v[36:39], v[88:91], v[168:171], v[36:39]
    v_and_b32 v96, v49, v8
    v_and_b32 v97, v49, v9
    v_and_b32 v98, v49, v10
    v_and_b32 v99, v49, v11
    s_waitcnt vmcnt(2)
    v_mfma_f32_16x16x32_bf16 v[36:39], v[92:95], v[172:175], v[36:39]
    s_waitcnt lgkmcnt(0)
    v_and_b32 v100, v50, v8
    v_and_b32 v101, v50, v9
    v_and_b32 v102, v50, v10
    v_and_b32 v103, v50, v11
    s_waitcnt vmcnt(1)
    v_mfma_f32_16x16x32_bf16 v[36:39], v[96:99], v[176:179], v[36:39]
    s_waitcnt vmcnt(0)
    v_mfma_f32_16x16x32_bf16 v[36:39], v[100:103], v[180:183], v[36:39]
    s_nop 7
    ds_write_b128 v17, v[36:39] offset:2048
    s_waitcnt lgkmcnt(0)
    s_barrier
    s_branch L_fin
L_AH1:
    s_load_dwordx2 s[20:21], s[0:1], s57
    s_load_dwordx2 s[24:25], s[0:1], 56
    s_load_dwordx2 s[28:29], s[0:1], 32
    s_load_dwordx2 s[32:33], s[0:1], 64
    s_load_dwordx2 s[36:37], s[0:1], 72
    s_load_dword s56, s[12:13], 0
    s_mov_b32 s14, 0x200000
    s_mov_b32 s15, 0x20000
    s_mov_b32 s22, 0x4000000
    s_mov_b32 s23, 0x20000
    s_mov_b32 s44, 0x7060500
    s_mov_b32 s45, 0x7060501
    s_mov_b32 s46, 0x7060502
    s_mov_b32 s47, 0x7060503
    s_mov_b32 s98, 0x3fb8aa3b
    s_mov_b32 s99, 0xffff0000
    v_lshrrev_b32 v6, 1, v2
    v_and_b32 v7, 1, v0
    v_lshl_add_u32 v7, v7, 4, v4
    v_xor_b32 v5, v3, v6
    v_lshl_add_u32 v28, v5, 5, v7
    v_xor_b32 v29, 128, v28
    s_cmp_lg_u32 s3, 4
    s_cbranch_scc1 L_nf15
    v_mov_b32 v6, 0
    v_mov_b32 v7, 0
    v_mov_b32 v4, 140544
    ds_write_b64 v4, v[6:7]
    ds_write_b64 v4, v[6:7] offset:8
    ds_write_b64 v4, v[6:7] offset:16
    ds_write_b64 v4, v[6:7] offset:24
    s_mov_b64 exec, 1
    buffer_load_dword v52, v6, s[12:15], 0 offen offset:2048 sc0
    s_mov_b64 exec, -1
L_nf15:
    s_sub_u32 s6, s3, 4
    s_lshl_b32 s4, s96, 12
    s_lshl_b32 s5, s6, 10
    s_add_u32 s4, s4, s5
    s_add_u32 s53, s4, 65536
    s_add_u32 s51, s53, 16384
    s_add_u32 s52, s51, 16384
    v_lshlrev_b32 v13, 4, v1
    v_lshrrev_b32 v4, 5, v1
    v_mul_u32_u24 v4, 272, v4
    v_and_b32 v5, 31, v0
    v_lshl_add_u32 v4, v5, 3, v4
    s_mul_i32 s4, s6, 544
    s_add_u32 s4, s4, 131072
    v_add_u32 v14, s4, v4
    v_and_b32 v6, 7, v0
    v_mul_u32_u24 v4, 272, v6
    v_lshl_add_u32 v4, v3, 4, v4
    v_add_u32 v19, 131072, v4
    v_xor_b32 v4, v3, v2
    v_lshlrev_b32 v4, 4, v4
    v_lshl_add_u32 v4, v2, 8, v4
    v_xor_b32 v5, 0, v4
    v_add_u32 v32, s50, v5
    v_xor_b32 v5, 64, v4
    v_add_u32 v33, s50, v5
    v_xor_b32 v5, 128, v4
    v_add_u32 v34, s50, v5
    v_xor_b32 v5, 192, v4
    v_add_u32 v35, s50, v5
    v_lshrrev_b32 v4, 2, v1
    v_and_b32 v5, 7, v4
    v_and_b32 v6, 3, v0
    v_lshlrev_b32 v6, 3, v6
    v_lshl_add_u32 v6, v4, 8, v6
    v_add_u32 v6, 65536, v6
    s_sub_u32 s4, s3, 4
    s_lshl_b32 s4, s4, 1
    v_xor_b32 v7, s4, v5
    v_lshl_add_u32 v23, v7, 5, v6
    v_xor_b32 v18, 32, v23
    v_and_b32 v6, 7, v0
    v_lshlrev_b32 v4, 5, v6
    v_add_u32 v69, 133376, v4
    s_lshl_b32 s4, s3, 2
    v_add_u32 v68, s4, v69
    s_lshl_b32 s4, s3, 8
    s_add_u32 s4, s4, 140608
    v_lshl_add_u32 v4, v1, 2, s4
    v_cmp_gt_u32 vcc, 8, v1
    s_nop 1
    v_cndmask_b32 v68, v4, v68, vcc
    v_lshlrev_b32 v4, 4, v6
    v_lshl_add_u32 v71, v3, 7, v4
    v_add_u32 v71, 133888, v71
    v_bfe_u32 v7, v0, 3, 1
    v_lshl_add_u32 v70, v7, 3, v71
    s_lshl_b32 s4, s3, 9
    v_add_u32 v70, s4, v70
    s_lshl_b32 s4, s96, 16
    s_lshl_b32 s5, s97, 9
    s_add_u32 s4, s4, s5
    s_lshl_b32 s5, s3, 6
    s_add_u32 s4, s4, s5
    s_add_u32 s54, s4, 262144
    v_lshlrev_b32 v4, 13, v6
    v_lshl_add_u32 v73, v3, 4, v4
    s_sub_u32 s5, s3, 8
    s_lshl_b32 s5, s5, 6
    s_add_u32 s54, s54, s5
    v_lshl_add_u32 v73, v7, 6, v73
    v_lshlrev_b32 v74, 4, v6
    s_lshl_b32 s5, s96, 11
    s_lshl_b32 s6, s97, 7
    s_add_u32 s5, s5, s6
    s_add_u32 s55, s5, 524288
    s_mov_b32 s60, 0xff00ff00
    s_mov_b32 s61, 0xff00ff00
    s_waitcnt lgkmcnt(0)
    s_add_u32 s56, s56, 0x01010101
    v_mov_b32 v12, s56
    s_bfe_u32 s40, s56, 0x80000
    s_bfe_u32 s41, s56, 0x80008
    s_bfe_u32 s42, s56, 0x80010
    s_bfe_u32 s43, s56, 0x80018
    s_waitcnt vmcnt(4)
    s_add_u32 m0, s50, 5120
    s_xor_b32 s49, s48, 40960
    buffer_load_dwordx4 v25, s[16:19], s49 offen nt lds
    s_waitcnt vmcnt(4)
    s_add_u32 m0, s50, 6144
    s_xor_b32 s49, s48, 49152
    buffer_load_dwordx4 v26, s[16:19], s49 offen nt lds
    s_waitcnt vmcnt(4)
    s_add_u32 m0, s50, 7168
    s_xor_b32 s49, s48, 57344
    buffer_load_dwordx4 v27, s[16:19], s49 offen nt lds
    s_waitcnt vmcnt(4)
    s_add_u32 m0, s50, 65536
    s_xor_b32 s49, s48, 0
    buffer_load_dwordx4 v28, s[20:23], s49 offen nt lds
    ds_read_b128 v[184:187], v32 offset:0
    ds_read_b128 v[188:191], v33 offset:0
    ds_read_b128 v[192:195], v34 offset:0
    ds_read_b128 v[196:199], v35 offset:0
    s_waitcnt vmcnt(4)
    s_add_u32 m0, s50, 66560
    s_xor_b32 s49, s48, 8192
    buffer_load_dwordx4 v29, s[20:23], s49 offen nt lds
    s_waitcnt vmcnt(4)
    s_add_u32 m0, s50, 67584
    s_xor_b32 s49, s48, 16384
    buffer_load_dwordx4 v28, s[20:23], s49 offen nt lds
    s_waitcnt vmcnt(4)
    s_add_u32 m0, s50, 68608
    s_xor_b32 s49, s48, 24576
    buffer_load_dwordx4 v29, s[20:23], s49 offen nt lds
    s_waitcnt vmcnt(4)
    s_add_u32 m0, s50, 69632
    s_xor_b32 s49, s48, 32768
    buffer_load_dwordx4 v28, s[20:23], s49 offen nt lds
    ds_read_b128 v[200:203], v32 offset:4096
    ds_read_b128 v[204:207], v33 offset:4096
    ds_read_b128 v[208:211], v34 offset:4096
    ds_read_b128 v[212:215], v35 offset:4096
    s_waitcnt vmcnt(4)
    s_add_u32 m0, s50, 70656
    s_xor_b32 s49, s48, 40960
    buffer_load_dwordx4 v29, s[20:23], s49 offen nt lds
    s_waitcnt vmcnt(4)
    s_add_u32 m0, s50, 71680
    s_xor_b32 s49, s48, 49152
    buffer_load_dwordx4 v28, s[20:23], s49 offen nt lds
    s_waitcnt vmcnt(4)
    s_add_u32 m0, s50, 72704
    s_xor_b32 s49, s48, 57344
    buffer_load_dwordx4 v29, s[20:23], s49 offen nt lds
    s_waitcnt vmcnt(3)
    buffer_load_dwordx4 v[76:79], v13, s[12:15], s53 offen sc1
    buffer_load_dwordx4 v[80:83], v13, s[12:15], s51 offen sc1
    buffer_load_dwordx4 v[84:87], v13, s[12:15], s52 offen sc1
    s_waitcnt vmcnt(0)
    s_mov_b32 s58, 0
    v_xor_b32 v76, s40, v76
    v_xor_b32 v77, s41, v77
    v_xor_b32 v78, s42, v78
    v_xor_b32 v79, s43, v79
    v_xor_b32 v80, s40, v80
    v_xor_b32 v81, s41, v81
    v_xor_b32 v82, s42, v82
    v_xor_b32 v83, s43, v83
    v_xor_b32 v84, s40, v84
    v_xor_b32 v85, s41, v85
    v_xor_b32 v86, s42, v86
    v_xor_b32 v87, s43, v87
    v_pk_add_f32 v[88:89], v[76:77], v[80:81]
    v_pk_add_f32 v[90:91], v[78:79], v[82:83]
    v_pk_add_f32 v[88:89], v[88:89], v[84:85]
    v_pk_add_f32 v[90:91], v[90:91], v[86:87]
    v_cvt_pk_bf16_f32 v88, v88, v89
    v_cvt_pk_bf16_f32 v89, v90, v91
    ds_write_b64 v14, v[88:89]
    v_or3_b32 v4, v76, v77, v78
    v_or3_b32 v5, v79, v80, v81
    v_or3_b32 v4, v4, v82, v83
    v_or3_b32 v5, v5, v84, v85
    v_or3_b32 v4, v4, v86, v87
    v_or_b32 v4, v4, v5
    v_cmp_ne_u32_sdwa vcc, v4, 0 src0_sel:BYTE_0 src1_sel:DWORD
    s_cbranch_vccz L_ok18
L_retry16:
    s_mov_b64 exec, vcc
    buffer_load_dwordx4 v[76:79], v13, s[12:15], s53 offen sc1
    buffer_load_dwordx4 v[80:83], v13, s[12:15], s51 offen sc1
    buffer_load_dwordx4 v[84:87], v13, s[12:15], s52 offen sc1
    s_add_u32 s58, s58, 1
    s_cmp_gt_u32 s58, 262144
    s_waitcnt vmcnt(0)
    s_cbranch_scc1 L_rex17
    v_xor_b32 v76, s40, v76
    v_xor_b32 v77, s41, v77
    v_xor_b32 v78, s42, v78
    v_xor_b32 v79, s43, v79
    v_xor_b32 v80, s40, v80
    v_xor_b32 v81, s41, v81
    v_xor_b32 v82, s42, v82
    v_xor_b32 v83, s43, v83
    v_xor_b32 v84, s40, v84
    v_xor_b32 v85, s41, v85
    v_xor_b32 v86, s42, v86
    v_xor_b32 v87, s43, v87
    v_or3_b32 v4, v76, v77, v78
    v_or3_b32 v5, v79, v80, v81
    v_or3_b32 v4, v4, v82, v83
    v_or3_b32 v5, v5, v84, v85
    v_or3_b32 v4, v4, v86, v87
    v_or_b32 v4, v4, v5
    v_cmp_ne_u32_sdwa vcc, v4, 0 src0_sel:BYTE_0 src1_sel:DWORD
    s_cbranch_vccnz L_retry16
L_rex17:
    s_mov_b64 exec, -1
    v_pk_add_f32 v[88:89], v[76:77], v[80:81]
    v_pk_add_f32 v[90:91], v[78:79], v[82:83]
    v_pk_add_f32 v[88:89], v[88:89], v[84:85]
    v_pk_add_f32 v[90:91], v[90:91], v[86:87]
    v_cvt_pk_bf16_f32 v88, v88, v89
    v_cvt_pk_bf16_f32 v89, v90, v91
    ds_write_b64 v14, v[88:89]
L_ok18:
    s_waitcnt lgkmcnt(0)
    s_barrier
    ds_read_b128 v[88:91], v19 offset:0
    ds_read_b128 v[92:95], v19 offset:64
    ds_read_b128 v[96:99], v19 offset:128
    ds_read_b128 v[100:103], v19 offset:192
    s_mov_b32 s4, 0x3db504f3
    s_mov_b32 s5, 0x3db504f3
    s_waitcnt lgkmcnt(3)
    v_mfma_f32_16x16x32_bf16 v[108:111], v[184:187], v[88:91], 0
    v_mfma_f32_16x16x32_bf16 v[112:115], v[200:203], v[88:91], 0
    s_waitcnt lgkmcnt(2)
    v_mfma_f32_16x16x32_bf16 v[108:111], v[188:191], v[92:95], v[108:111]
    v_mfma_f32_16x16x32_bf16 v[112:115], v[204:207], v[92:95], v[112:115]
    s_waitcnt lgkmcnt(1)
    v_mfma_f32_16x16x32_bf16 v[108:111], v[192:195], v[96:99], v[108:111]
    v_mfma_f32_16x16x32_bf16 v[112:115], v[208:211], v[96:99], v[112:115]
    s_waitcnt lgkmcnt(0)
    v_mfma_f32_16x16x32_bf16 v[108:111], v[196:199], v[100:103], v[108:111]
    v_mfma_f32_16x16x32_bf16 v[112:115], v[212:215], v[100:103], v[112:115]
    s_nop 7
    v_cndmask_b32 v60, v108, v112, s[60:61]
    v_cndmask_b32 v61, v109, v113, s[60:61]
    v_cndmask_b32 v62, v110, v114, s[60:61]
    v_cndmask_b32 v63, v111, v115, s[60:61]
    v_cvt_pk_bf16_f32 v108, v60, v61
    v_cvt_pk_bf16_f32 v109, v62, v63
    v_lshlrev_b32 v60, 16, v108
    v_and_b32 v61, s99, v108
    v_lshlrev_b32 v62, 16, v109
    v_and_b32 v63, s99, v109
    v_pk_mul_f32 v[60:61], v[60:61], s[4:5]
    v_pk_mul_f32 v[62:63], v[62:63], s[4:5]
    v_cvt_pk_bf16_f32 v108, v60, v61
    v_cvt_pk_bf16_f32 v109, v62, v63
    v_lshlrev_b32 v60, 16, v108
    v_and_b32 v61, s99, v108
    v_lshlrev_b32 v62, 16, v109
    v_and_b32 v63, s99, v109
    v_max3_f32 v72, v60, v61, v62
    v_max_f32 v72, v72, v63
    s_nop 1
    v_max_f32_dpp v72, v72, v72 row_ror:8 row_mask:0xf bank_mask:0xf
    v_mov_b32 v5, v72
    s_nop 1
    v_permlane16_swap_b32 v72, v5
    v_max_f32 v72, v72, v5
    v_mov_b32 v5, v72
    s_nop 1
    v_permlane32_swap_b32 v72, v5
    v_max_f32 v72, v72, v5
    ds_write_b32 v68, v72
    s_waitcnt lgkmcnt(0)
    s_barrier
    ds_read_b128 v[108:111], v69
    ds_read_b128 v[112:115], v69 offset:16
    s_waitcnt lgkmcnt(0)
    v_max3_f32 v72, v108, v109, v110
    v_max3_f32 v4, v111, v112, v113
    v_max3_f32 v72, v72, v114, v115
    v_max_f32 v72, v72, v4
    v_mul_f32 v4, s98, v72
    v_fma_f32 v60, v60, s98, -v4
    v_fma_f32 v61, v61, s98, -v4
    v_fma_f32 v62, v62, s98, -v4
    v_fma_f32 v63, v63, s98, -v4
    v_exp_f32 v60, v60
    v_exp_f32 v61, v61
    v_exp_f32 v62, v62
    v_exp_f32 v63, v63
    v_cvt_pk_bf16_f32 v108, v60, v61
    v_cvt_pk_bf16_f32 v109, v62, v63
    ds_write_b64 v70, v[108:109]
    v_add_f32 v60, v60, v61
    v_add_f32 v62, v62, v63
    v_add_f32 v4, v60, v62
    s_nop 1
    v_add_f32_dpp v4, v4, v4 row_ror:8 row_mask:0xf bank_mask:0xf
    v_mov_b32 v5, v4
    s_nop 1
    v_permlane16_swap_b32 v4, v5
    v_add_f32 v4, v4, v5
    v_mov_b32 v5, v4
    s_nop 1
    v_permlane32_swap_b32 v4, v5
    v_add_f32 v4, v4, v5
    ds_write_b32 v68, v4 offset:256
    s_waitcnt lgkmcnt(0)
    s_barrier
    ds_read_b128 v[76:79], v71 offset:0
    ds_read_b64_tr_b16 v[184:185], v23 offset:0
    ds_read_b64_tr_b16 v[186:187], v23 offset:4096
    ds_read_b64_tr_b16 v[188:189], v18 offset:0
    ds_read_b64_tr_b16 v[190:191], v18 offset:4096
    ds_read_b128 v[80:83], v71 offset:512
    ds_read_b64_tr_b16 v[192:193], v23 offset:8192
    ds_read_b64_tr_b16 v[194:195], v23 offset:12288
    ds_read_b64_tr_b16 v[196:197], v18 offset:8192
    ds_read_b64_tr_b16 v[198:199], v18 offset:12288
    ds_read_b128 v[84:87], v71 offset:1024
    ds_read_b64_tr_b16 v[200:201], v23 offset:16384
    ds_read_b64_tr_b16 v[202:203], v23 offset:20480
    ds_read_b64_tr_b16 v[204:205], v18 offset:16384
    ds_read_b64_tr_b16 v[206:207], v18 offset:20480
    s_waitcnt lgkmcnt(10)
    v_mfma_f32_16x16x32_bf16 v[248:251], v[184:187], v[76:79], 0
    v_mfma_f32_16x16x32_bf16 v[252:255], v[188:191], v[76:79], 0
    ds_read_b128 v[88:91], v71 offset:1536
    ds_read_b64_tr_b16 v[208:209], v23 offset:24576
    ds_read_b64_tr_b16 v[210:211], v23 offset:28672
    ds_read_b64_tr_b16 v[212:213], v18 offset:24576
    ds_read_b64_tr_b16 v[214:215], v18 offset:28672
    s_waitcnt lgkmcnt(10)
    v_mfma_f32_16x16x32_bf16 v[248:251], v[192:195], v[80:83], v[248:251]
    v_mfma_f32_16x16x32_bf16 v[252:255], v[196:199], v[80:83], v[252:255]
    ds_read_b128 v[92:95], v71 offset:2048
    ds_read_b64_tr_b16 v[216:217], v23 offset:32768
    ds_read_b64_tr_b16 v[218:219], v23 offset:36864
    ds_read_b64_tr_b16 v[220:221], v18 offset:32768
    ds_read_b64_tr_b16 v[222:223], v18 offset:36864
    s_waitcnt lgkmcnt(10)
    v_mfma_f32_16x16x32_bf16 v[248:251], v[200:203], v[84:87], v[248:251]
    v_mfma_f32_16x16x32_bf16 v[252:255], v[204:207], v[84:87], v[252:255]
    ds_read_b128 v[96:99], v71 offset:2560
    ds_read_b64_tr_b16 v[224:225], v23 offset:40960
    ds_read_b64_tr_b16 v[226:227], v23 offset:45056
    ds_read_b64_tr_b16 v[228:229], v18 offset:40960
    ds_read_b64_tr_b16 v[230:231], v18 offset:45056
    s_waitcnt lgkmcnt(10)
    v_mfma_f32_16x16x32_bf16 v[248:251], v[208:211], v[88:91], v[248:251]
    v_mfma_f32_16x16x32_bf16 v[252:255], v[212:215], v[88:91], v[252:255]
    ds_read_b128 v[100:103], v71 offset:3072
    ds_read_b64_tr_b16 v[232:233], v23 offset:49152
    ds_read_b64_tr_b16 v[234:235], v23 offset:53248
    ds_read_b64_tr_b16 v[236:237], v18 offset:49152
    ds_read_b64_tr_b16 v[238:239], v18 offset:53248
    s_waitcnt lgkmcnt(10)
    v_mfma_f32_16x16x32_bf16 v[248:251], v[216:219], v[92:95], v[248:251]
    v_mfma_f32_16x16x32_bf16 v[252:255], v[220:223], v[92:95], v[252:255]
    ds_read_b128 v[104:107], v71 offset:3584
    ds_read_b64_tr_b16 v[240:241], v23 offset:57344
    ds_read_b64_tr_b16 v[242:243], v23 offset:61440
    ds_read_b64_tr_b16 v[244:245], v18 offset:57344
    ds_read_b64_tr_b16 v[246:247], v18 offset:61440
    s_waitcnt lgkmcnt(10)
    v_mfma_f32_16x16x32_bf16 v[248:251], v[224:227], v[96:99], v[248:251]
    v_mfma_f32_16x16x32_bf16 v[252:255], v[228:231], v[96:99], v[252:255]
    s_waitcnt lgkmcnt(5)
    v_mfma_f32_16x16x32_bf16 v[248:251], v[232:235], v[100:103], v[248:251]
    v_mfma_f32_16x16x32_bf16 v[252:255], v[236:239], v[100:103], v[252:255]
    s_waitcnt lgkmcnt(0)
    v_mfma_f32_16x16x32_bf16 v[248:251], v[240:243], v[104:107], v[248:251]
    v_mfma_f32_16x16x32_bf16 v[252:255], v[244:247], v[104:107], v[252:255]
    s_nop 7
    v_cndmask_b32 v108, v248, v252, s[60:61]
    v_cndmask_b32 v109, v249, v253, s[60:61]
    v_cndmask_b32 v110, v250, v254, s[60:61]
    v_cndmask_b32 v111, v251, v255, s[60:61]
    v_perm_b32 v108, v108, v12, s44
    v_perm_b32 v109, v109, v12, s45
    v_perm_b32 v110, v110, v12, s46
    v_perm_b32 v111, v111, v12, s47
    buffer_store_dwordx4 v[108:111], v73, s[12:15], s54 offen sc1
    s_cmp_lg_u32 s3, 7
    s_cbranch_scc1 L_AH7
    s_lshr_b32 s4, s2, 3
    s_and_b32 s5, s2, 7
    s_lshl_b32 s5, s5, 9
    s_lshl_b32 s4, s4, 4
    s_add_u32 s4, s4, s5
    s_add_u32 s4, s4, 589824
    s_getreg_b32 s5, hwreg(HW_REG_XCC_ID, 0, 4)
    s_lshl_b32 s5, s5, 8
    s_or_b32 s6, s5, s40
    v_mov_b32 v116, s6
    s_or_b32 s6, s5, s41
    v_mov_b32 v117, s6
    s_or_b32 s6, s5, s42
    v_mov_b32 v118, s6
    s_or_b32 s6, s5, s43
    v_mov_b32 v119, s6
    v_mov_b32 v4, 0
    s_mov_b64 exec, 1
    buffer_store_dwordx4 v[116:119], v4, s[12:15], s4 offen sc1
    s_mov_b64 exec, -1
L_AH7:
    s_setprio 2
    s_branch L_HELP
L_HELP:
    s_lshr_b32 s51, s2, 3
    s_and_b32 s52, s2, 7
    v_mov_b32 v16, 140544
    s_cmp_ge_u32 s3, 6
    s_cbranch_scc1 L_HH
    s_lshr_b32 s51, s2, 3
    s_and_b32 s52, s2, 7
    s_sub_u32 s4, s3, 4
    s_lshl_b32 s53, s51, 13
    s_lshl_b32 s5, s4, 8
    s_add_u32 s53, s53, s5
    s_add_u32 s53, s53, 262144
    v_lshlrev_b32 v4, 4, v2
    v_lshl_add_u32 v13, v3, 11, v4
    s_add_u32 s5, s5, 137984
    v_add_u32 v15, s5, v4
    v_lshl_add_u32 v15, v3, 2, v15
    s_lshr_b32 s54, s51, 3
    s_lshl_b32 s54, s54, 11
    s_and_b32 s5, s51, 7
    s_lshl_b32 s5, s5, 4
    s_add_u32 s54, s54, s5
    s_add_u32 s54, s54, 524288
    v_lshl_add_u32 v5, v3, 2, v2
    v_and_b32 v5, 15, v5
    v_lshlrev_b32 v14, 7, v5
    s_lshl_b32 s4, s4, 2
    v_add_u32 v17, s4, v16
    s_mov_b32 s7, 0
L_wf19:
    ds_read_b32 v4, v16 offset:16
    s_add_u32 s7, s7, 1
    s_cmp_gt_u32 s7, 4194304
    s_waitcnt lgkmcnt(0)
    s_cbranch_scc1 L_wfd20
    v_cmp_ne_u32 vcc, 0, v4
    s_cbranch_vccnz L_wfd20
    s_branch L_wf19
L_wfd20:
    s_mov_b32 s58, 1
    buffer_load_dwordx4 v[36:39], v14, s[12:15], s54 offen sc1
    buffer_load_dwordx4 v[20:23], v13, s[12:15], s53 offen offset:0 sc1
    buffer_load_dwordx4 v[24:27], v13, s[12:15], s53 offen offset:512 sc1
    buffer_load_dwordx4 v[28:31], v13, s[12:15], s53 offen offset:1024 sc1
    buffer_load_dwordx4 v[32:35], v13, s[12:15], s53 offen offset:1536 sc1
    s_waitcnt vmcnt(4)
    v_xor_b32 v44, s40, v36
    v_xor_b32 v45, s41, v37
    v_mov_b32 v7, v44
    s_nop 1
    v_max_f32_dpp v7, v7, v7 row_ror:1 row_mask:0xf bank_mask:0xf
    s_nop 1
    v_max_f32_dpp v7, v7, v7 row_ror:2 row_mask:0xf bank_mask:0xf
    s_nop 1
    v_max_f32_dpp v7, v7, v7 row_ror:4 row_mask:0xf bank_mask:0xf
    s_nop 1
    v_max_f32_dpp v7, v7, v7 row_ror:8 row_mask:0xf bank_mask:0xf
    v_sub_f32 v7, v44, v7
    v_mul_f32 v7, s98, v7
    v_exp_f32 v7, v7
    s_nop 0
    v_mul_f32 v45, v7, v45
    s_nop 1
    v_add_f32_dpp v45, v45, v45 row_ror:1 row_mask:0xf bank_mask:0xf
    s_nop 1
    v_add_f32_dpp v45, v45, v45 row_ror:2 row_mask:0xf bank_mask:0xf
    s_nop 1
    v_add_f32_dpp v45, v45, v45 row_ror:4 row_mask:0xf bank_mask:0xf
    s_nop 1
    v_add_f32_dpp v45, v45, v45 row_ror:8 row_mask:0xf bank_mask:0xf
    v_rcp_f32 v44, v45
    s_nop 0
    v_fma_f32 v45, -v44, v45, 1.0
    v_fma_f32 v44, v45, v44, v44
    v_mul_f32 v7, v7, v44
    s_waitcnt vmcnt(0)
    v_xor_b32 v36, s40, v36
    v_xor_b32 v37, s41, v37
    v_xor_b32 v38, s42, v38
    v_xor_b32 v39, s43, v39
    v_xor_b32 v20, s40, v20
    v_xor_b32 v21, s41, v21
    v_xor_b32 v22, s42, v22
    v_xor_b32 v23, s43, v23
    v_xor_b32 v24, s40, v24
    v_xor_b32 v25, s41, v25
    v_xor_b32 v26, s42, v26
    v_xor_b32 v27, s43, v27
    v_xor_b32 v28, s40, v28
    v_xor_b32 v29, s41, v29
    v_xor_b32 v30, s42, v30
    v_xor_b32 v31, s43, v31
    v_xor_b32 v32, s40, v32
    v_xor_b32 v33, s41, v33
    v_xor_b32 v34, s42, v34
    v_xor_b32 v35, s43, v35
    v_or3_b32 v4, v36, v37, v38
    v_or3_b32 v5, v39, v20, v21
    v_or3_b32 v4, v4, v22, v23
    v_or3_b32 v5, v5, v24, v25
    v_or3_b32 v4, v4, v26, v27
    v_or3_b32 v5, v5, v28, v29
    v_or3_b32 v4, v4, v30, v31
    v_or3_b32 v5, v5, v32, v33
    v_or3_b32 v4, v4, v34, v35
    v_or_b32 v4, v4, v5
    v_cmp_ne_u32_sdwa vcc, v4, 0 src0_sel:BYTE_0 src1_sel:DWORD
    s_cbranch_vccz L_ok23
L_retry21:
    s_mov_b64 exec, vcc
    buffer_load_dwordx4 v[36:39], v14, s[12:15], s54 offen sc1
    buffer_load_dwordx4 v[20:23], v13, s[12:15], s53 offen offset:0 sc1
    buffer_load_dwordx4 v[24:27], v13, s[12:15], s53 offen offset:512 sc1
    buffer_load_dwordx4 v[28:31], v13, s[12:15], s53 offen offset:1024 sc1
    buffer_load_dwordx4 v[32:35], v13, s[12:15], s53 offen offset:1536 sc1
    s_add_u32 s58, s58, 1
    s_cmp_gt_u32 s58, 262144
    s_waitcnt vmcnt(0)
    s_cbranch_scc1 L_rex22
    v_xor_b32 v36, s40, v36
    v_xor_b32 v37, s41, v37
    v_xor_b32 v38, s42, v38
    v_xor_b32 v39, s43, v39
    v_xor_b32 v20, s40, v20
    v_xor_b32 v21, s41, v21
    v_xor_b32 v22, s42, v22
    v_xor_b32 v23, s43, v23
    v_xor_b32 v24, s40, v24
    v_xor_b32 v25, s41, v25
    v_xor_b32 v26, s42, v26
    v_xor_b32 v27, s43, v27
    v_xor_b32 v28, s40, v28
    v_xor_b32 v29, s41, v29
    v_xor_b32 v30, s42, v30
    v_xor_b32 v31, s43, v31
    v_xor_b32 v32, s40, v32
    v_xor_b32 v33, s41, v33
    v_xor_b32 v34, s42, v34
    v_xor_b32 v35, s43, v35
    v_or3_b32 v4, v36, v37, v38
    v_or3_b32 v5, v39, v20, v21
    v_or3_b32 v4, v4, v22, v23
    v_or3_b32 v5, v5, v24, v25
    v_or3_b32 v4, v4, v26, v27
    v_or3_b32 v5, v5, v28, v29
    v_or3_b32 v4, v4, v30, v31
    v_or3_b32 v5, v5, v32, v33
    v_or3_b32 v4, v4, v34, v35
    v_or_b32 v4, v4, v5
    v_cmp_ne_u32_sdwa vcc, v4, 0 src0_sel:BYTE_0 src1_sel:DWORD
    s_cbranch_vccnz L_retry21
L_rex22:
    s_mov_b64 exec, -1
    v_mov_b32 v44, v36
    v_mov_b32 v45, v37
    v_mov_b32 v7, v44
    s_nop 1
    v_max_f32_dpp v7, v7, v7 row_ror:1 row_mask:0xf bank_mask:0xf
    s_nop 1
    v_max_f32_dpp v7, v7, v7 row_ror:2 row_mask:0xf bank_mask:0xf
    s_nop 1
    v_max_f32_dpp v7, v7, v7 row_ror:4 row_mask:0xf bank_mask:0xf
    s_nop 1
    v_max_f32_dpp v7, v7, v7 row_ror:8 row_mask:0xf bank_mask:0xf
    v_sub_f32 v7, v44, v7
    v_mul_f32 v7, s98, v7
    v_exp_f32 v7, v7
    s_nop 0
    v_mul_f32 v45, v7, v45
    s_nop 1
    v_add_f32_dpp v45, v45, v45 row_ror:1 row_mask:0xf bank_mask:0xf
    s_nop 1
    v_add_f32_dpp v45, v45, v45 row_ror:2 row_mask:0xf bank_mask:0xf
    s_nop 1
    v_add_f32_dpp v45, v45, v45 row_ror:4 row_mask:0xf bank_mask:0xf
    s_nop 1
    v_add_f32_dpp v45, v45, v45 row_ror:8 row_mask:0xf bank_mask:0xf
    v_rcp_f32 v44, v45
    s_nop 0
    v_fma_f32 v45, -v44, v45, 1.0
    v_fma_f32 v44, v45, v44, v44
    v_mul_f32 v7, v7, v44
L_ok23:
    s_nop 1
    v_mul_f32_dpp v40, v7, v20 row_newbcast:0 row_mask:0xf bank_mask:0xf
    v_mul_f32_dpp v41, v7, v21 row_newbcast:0 row_mask:0xf bank_mask:0xf
    v_mul_f32_dpp v42, v7, v22 row_newbcast:0 row_mask:0xf bank_mask:0xf
    v_mul_f32_dpp v43, v7, v23 row_newbcast:0 row_mask:0xf bank_mask:0xf
    v_fmac_f32_dpp v40, v7, v24 row_newbcast:1 row_mask:0xf bank_mask:0xf
    v_fmac_f32_dpp v41, v7, v25 row_newbcast:1 row_mask:0xf bank_mask:0xf
    v_fmac_f32_dpp v42, v7, v26 row_newbcast:1 row_mask:0xf bank_mask:0xf
    v_fmac_f32_dpp v43, v7, v27 row_newbcast:1 row_mask:0xf bank_mask:0xf
    v_fmac_f32_dpp v40, v7, v28 row_newbcast:2 row_mask:0xf bank_mask:0xf
    v_fmac_f32_dpp v41, v7, v29 row_newbcast:2 row_mask:0xf bank_mask:0xf
    v_fmac_f32_dpp v42, v7, v30 row_newbcast:2 row_mask:0xf bank_mask:0xf
    v_fmac_f32_dpp v43, v7, v31 row_newbcast:2 row_mask:0xf bank_mask:0xf
    v_fmac_f32_dpp v40, v7, v32 row_newbcast:3 row_mask:0xf bank_mask:0xf
    v_fmac_f32_dpp v41, v7, v33 row_newbcast:3 row_mask:0xf bank_mask:0xf
    v_fmac_f32_dpp v42, v7, v34 row_newbcast:3 row_mask:0xf bank_mask:0xf
    v_fmac_f32_dpp v43, v7, v35 row_newbcast:3 row_mask:0xf bank_mask:0xf
    v_mov_b32 v4, 4
    v_permlane32_swap_b32 v40, v42
    v_permlane32_swap_b32 v41, v43
    v_pk_add_f32 v[40:41], v[40:41], v[42:43]
    s_nop 1
    v_permlane16_swap_b32 v40, v41
    v_add_f32 v40, v40, v41
    v_cvt_pk_bf16_f32 v40, v40, v40
    ds_write_b32 v15, v40
    ds_write_b32 v17, v4
    s_cmp_lg_u32 s2, 248
    s_cbranch_scc1 L_fin
    s_cmp_lg_u32 s3, 4
    s_cbranch_scc1 L_fin
    v_lshlrev_b32 v13, 4, v1
    s_mov_b32 s53, 589824
    s_mov_b32 s54, 590848
    s_mov_b32 s55, 591872
    s_mov_b32 s48, 592896
    s_mov_b32 s58, 1
    buffer_load_dwordx4 v[20:23], v13, s[12:15], s53 offen sc1
    buffer_load_dwordx4 v[24:27], v13, s[12:15], s54 offen sc1
    buffer_load_dwordx4 v[28:31], v13, s[12:15], s55 offen sc1
    buffer_load_dwordx4 v[32:35], v13, s[12:15], s48 offen sc1
    s_waitcnt vmcnt(0)
    v_xor_b32 v20, s40, v20
    v_xor_b32 v21, s41, v21
    v_xor_b32 v22, s42, v22
    v_xor_b32 v23, s43, v23
    v_xor_b32 v24, s40, v24
    v_xor_b32 v25, s41, v25
    v_xor_b32 v26, s42, v26
    v_xor_b32 v27, s43, v27
    v_xor_b32 v28, s40, v28
    v_xor_b32 v29, s41, v29
    v_xor_b32 v30, s42, v30
    v_xor_b32 v31, s43, v31
    v_xor_b32 v32, s40, v32
    v_xor_b32 v33, s41, v33
    v_xor_b32 v34, s42, v34
    v_xor_b32 v35, s43, v35
    v_or3_b32 v4, v20, v21, v22
    v_or3_b32 v5, v23, v24, v25
    v_or3_b32 v4, v4, v26, v27
    v_or3_b32 v5, v5, v28, v29
    v_or3_b32 v4, v4, v30, v31
    v_or3_b32 v5, v5, v32, v33
    v_or3_b32 v4, v4, v34, v35
    v_or_b32 v4, v4, v5
    v_cmp_ne_u32_sdwa vcc, v4, 0 src0_sel:BYTE_0 src1_sel:DWORD
    s_cbranch_vccz L_ok26
L_retry24:
    s_mov_b64 exec, vcc
    buffer_load_dwordx4 v[20:23], v13, s[12:15], s53 offen sc1
    buffer_load_dwordx4 v[24:27], v13, s[12:15], s54 offen sc1
    buffer_load_dwordx4 v[28:31], v13, s[12:15], s55 offen sc1
    buffer_load_dwordx4 v[32:35], v13, s[12:15], s48 offen sc1
    s_add_u32 s58, s58, 1
    s_cmp_gt_u32 s58, 262144
    s_waitcnt vmcnt(0)
    s_cbranch_scc1 L_rex25
    v_xor_b32 v20, s40, v20
    v_xor_b32 v21, s41, v21
    v_xor_b32 v22, s42, v22
    v_xor_b32 v23, s43, v23
    v_xor_b32 v24, s40, v24
    v_xor_b32 v25, s41, v25
    v_xor_b32 v26, s42, v26
    v_xor_b32 v27, s43, v27
    v_xor_b32 v28, s40, v28
    v_xor_b32 v29, s41, v29
    v_xor_b32 v30, s42, v30
    v_xor_b32 v31, s43, v31
    v_xor_b32 v32, s40, v32
    v_xor_b32 v33, s41, v33
    v_xor_b32 v34, s42, v34
    v_xor_b32 v35, s43, v35
    v_or3_b32 v4, v20, v21, v22
    v_or3_b32 v5, v23, v24, v25
    v_or3_b32 v4, v4, v26, v27
    v_or3_b32 v5, v5, v28, v29
    v_or3_b32 v4, v4, v30, v31
    v_or3_b32 v5, v5, v32, v33
    v_or3_b32 v4, v4, v34, v35
    v_or_b32 v4, v4, v5
    v_cmp_ne_u32_sdwa vcc, v4, 0 src0_sel:BYTE_0 src1_sel:DWORD
    s_cbranch_vccnz L_retry24
L_rex25:
    s_mov_b64 exec, -1
L_ok26:
    s_mov_b64 exec, 1
    buffer_store_dword v12, v13, s[12:15], 0 offen sc1
    s_mov_b64 exec, -1
    s_branch L_fin
L_HH:
    s_and_b32 s5, s51, 24
    s_lshr_b32 s48, 0x1c1c1c1c, s5
    s_and_b32 s48, s48, 0xff
    s_and_b32 s5, s51, 7
    s_cmp_eq_u32 s5, 7
    s_cselect_b32 s5, 1, 0
    s_cmp_ge_u32 s51, 8
    s_cselect_b32 s5, s5, 0
    s_mov_b32 s50, s5
    s_cmp_eq_u32 s5, 1
    s_cselect_b32 s48, 14, s48
    s_cbranch_scc1 L_HH2
    s_cmp_eq_u32 s3, 7
    s_cbranch_scc1 L_HF
L_HH2:
    s_mul_i32 s6, s51, 7
    s_lshl_b32 s6, s6, 4
    v_and_b32 v5, 31, v0
    v_lshrrev_b32 v4, 5, v1
    v_lshlrev_b32 v6, 4, v5
    v_lshl_add_u32 v6, v4, 3, v6
    s_sub_u32 s5, s3, 6
    s_mul_i32 s7, s5, 56
    s_add_u32 s6, s6, s7
    s_lshl_b32 s7, s7, 2
    s_add_u32 s7, s7, 138496
    v_add_u32 v15, s7, v6
    s_lshl_b32 s5, s5, 2
    v_add_u32 v18, s5, v16
    s_lshl_b32 s53, s6, 2
    s_add_u32 s53, s53, 131072
    s_add_u32 s54, s53, 14336
    s_add_u32 s55, s54, 14336
    v_mul_u32_u24 v4, 43008, v4
    v_lshl_add_u32 v4, v5, 4, v4
    v_lshl_add_u32 v6, v5, 2, s6
    v_mov_b32 v7, 0x7ff00000
    v_cmp_gt_u32 s[60:61], s48, v5
    v_cmp_gt_u32 vcc, 0xe00, v6
    s_and_b64 s[62:63], s[60:61], vcc
    v_cndmask_b32 v13, v7, v4, s[62:63]
    s_mov_b32 s4, 0xbdd2d3e8
    v_mov_b32 v14, 0xc0135761
    s_mov_b32 s5, s4
    v_mov_b32 v40, v14
    v_mov_b32 v41, v14
    s_cmp_eq_u32 s50, 1
    s_cselect_b32 s5, 0, 20
    v_add_u32 v17, s5, v16
    s_mov_b32 s5, s4
    s_mov_b32 s7, 0
L_wf27:
    ds_read_b32 v4, v17 offset:0
    s_add_u32 s7, s7, 1
    s_cmp_gt_u32 s7, 4194304
    s_waitcnt lgkmcnt(0)
    s_cbranch_scc1 L_wfd28
    v_cmp_ne_u32 vcc, 0, v4
    s_cbranch_vccnz L_wfd28
    s_branch L_wf27
L_wfd28:
    s_mov_b32 s58, 1
    buffer_load_dwordx4 v[20:23], v13, s[12:15], s53 offen offset:0 sc1
    buffer_load_dwordx4 v[24:27], v13, s[12:15], s54 offen offset:0 sc1
    buffer_load_dwordx4 v[28:31], v13, s[12:15], s55 offen offset:0 sc1
    s_waitcnt vmcnt(0)
    v_xor_b32 v20, s40, v20
    v_xor_b32 v21, s41, v21
    v_xor_b32 v22, s42, v22
    v_xor_b32 v23, s43, v23
    v_xor_b32 v24, s40, v24
    v_xor_b32 v25, s41, v25
    v_xor_b32 v26, s42, v26
    v_xor_b32 v27, s43, v27
    v_xor_b32 v28, s40, v28
    v_xor_b32 v29, s41, v29
    v_xor_b32 v30, s42, v30
    v_xor_b32 v31, s43, v31
    v_pk_add_f32 v[44:45], v[20:21], v[24:25]
    v_pk_add_f32 v[46:47], v[22:23], v[26:27]
    v_pk_add_f32 v[44:45], v[44:45], v[28:29]
    v_pk_add_f32 v[46:47], v[46:47], v[30:31]
    v_cvt_pk_bf16_f32 v4, v44, v45
    v_cvt_pk_bf16_f32 v5, v46, v47
    s_nop 1
    v_permlane32_swap_b32 v4, v5
    v_lshlrev_b32 v44, 16, v4
    v_and_b32 v45, s99, v4
    v_lshlrev_b32 v46, 16, v5
    v_and_b32 v47, s99, v5
    v_pk_mul_f32 v[48:49], v[44:45], v[44:45]
    v_pk_fma_f32 v[48:49], v[48:49], s[4:5], v[40:41]
    v_pk_mul_f32 v[48:49], v[48:49], v[44:45]
    v_exp_f32 v48, v48
    v_exp_f32 v49, v49
    s_nop 0
    v_pk_add_f32 v[48:49], v[48:49], 1.0 op_sel_hi:[1,0]
    v_rcp_f32 v48, v48
    v_rcp_f32 v49, v49
    s_nop 0
    v_pk_mul_f32 v[48:49], v[48:49], v[44:45]
    v_cvt_pk_bf16_f32 v4, v48, v49
    v_lshlrev_b32 v48, 16, v4
    v_and_b32 v49, s99, v4
    v_pk_mul_f32 v[48:49], v[48:49], v[46:47]
    s_mov_b64 exec, s[60:61]
    v_cvt_pk_bf16_f32 v48, v48, v48
    v_cvt_pk_bf16_f32 v49, v49, v49
    ds_write_b64 v15, v[48:49]
    s_mov_b64 exec, -1
    v_or3_b32 v4, v20, v21, v22
    v_or3_b32 v5, v23, v24, v25
    v_or3_b32 v4, v4, v26, v27
    v_or3_b32 v5, v5, v28, v29
    v_or3_b32 v4, v4, v30, v31
    v_or_b32 v4, v4, v5
    v_cmp_ne_u32_sdwa vcc, v4, 0 src0_sel:BYTE_0 src1_sel:DWORD
    s_and_b64 vcc, vcc, s[62:63]
    s_cbranch_vccz L_ok31
L_retry29:
    s_mov_b64 exec, vcc
    buffer_load_dwordx4 v[20:23], v13, s[12:15], s53 offen offset:0 sc1
    buffer_load_dwordx4 v[24:27], v13, s[12:15], s54 offen offset:0 sc1
    buffer_load_dwordx4 v[28:31], v13, s[12:15], s55 offen offset:0 sc1
    s_add_u32 s58, s58, 1
    s_cmp_gt_u32 s58, 262144
    s_waitcnt vmcnt(0)
    s_cbranch_scc1 L_rex30
    v_xor_b32 v20, s40, v20
    v_xor_b32 v21, s41, v21
    v_xor_b32 v22, s42, v22
    v_xor_b32 v23, s43, v23
    v_xor_b32 v24, s40, v24
    v_xor_b32 v25, s41, v25
    v_xor_b32 v26, s42, v26
    v_xor_b32 v27, s43, v27
    v_xor_b32 v28, s40, v28
    v_xor_b32 v29, s41, v29
    v_xor_b32 v30, s42, v30
    v_xor_b32 v31, s43, v31
    v_or3_b32 v4, v20, v21, v22
    v_or3_b32 v5, v23, v24, v25
    v_or3_b32 v4, v4, v26, v27
    v_or3_b32 v5, v5, v28, v29
    v_or3_b32 v4, v4, v30, v31
    v_or_b32 v4, v4, v5
    v_cmp_ne_u32_sdwa vcc, v4, 0 src0_sel:BYTE_0 src1_sel:DWORD
    s_and_b64 vcc, vcc, s[62:63]
    s_cbranch_vccnz L_retry29
L_rex30:
    s_mov_b64 exec, -1
    v_pk_add_f32 v[44:45], v[20:21], v[24:25]
    v_pk_add_f32 v[46:47], v[22:23], v[26:27]
    v_pk_add_f32 v[44:45], v[44:45], v[28:29]
    v_pk_add_f32 v[46:47], v[46:47], v[30:31]
    v_cvt_pk_bf16_f32 v4, v44, v45
    v_cvt_pk_bf16_f32 v5, v46, v47
    s_nop 1
    v_permlane32_swap_b32 v4, v5
    v_lshlrev_b32 v44, 16, v4
    v_and_b32 v45, s99, v4
    v_lshlrev_b32 v46, 16, v5
    v_and_b32 v47, s99, v5
    v_pk_mul_f32 v[48:49], v[44:45], v[44:45]
    v_pk_fma_f32 v[48:49], v[48:49], s[4:5], v[40:41]
    v_pk_mul_f32 v[48:49], v[48:49], v[44:45]
    v_exp_f32 v48, v48
    v_exp_f32 v49, v49
    s_nop 0
    v_pk_add_f32 v[48:49], v[48:49], 1.0 op_sel_hi:[1,0]
    v_rcp_f32 v48, v48
    v_rcp_f32 v49, v49
    s_nop 0
    v_pk_mul_f32 v[48:49], v[48:49], v[44:45]
    v_cvt_pk_bf16_f32 v4, v48, v49
    v_lshlrev_b32 v48, 16, v4
    v_and_b32 v49, s99, v4
    v_pk_mul_f32 v[48:49], v[48:49], v[46:47]
    s_mov_b64 exec, s[60:61]
    v_cvt_pk_bf16_f32 v48, v48, v48
    v_cvt_pk_bf16_f32 v49, v49, v49
    ds_write_b64 v15, v[48:49]
    s_mov_b64 exec, -1
L_ok31:
    s_cmp_eq_u32 s3, 7
    s_waitcnt lgkmcnt(0)
    s_cbranch_scc1 L_HF
    s_barrier
    s_branch L_fin
L_HF:
    s_lshl_b32 s53, s52, 14
    s_lshl_b32 s7, s51, 9
    s_add_u32 s53, s53, s7
    s_add_u32 s53, s53, 1048576
    s_add_u32 s54, s53, 524288
    v_and_b32 v5, 31, v0
    v_lshlrev_b32 v13, 4, v5
    v_add_u32 v14, 131072, v13
    v_add_u32 v15, 140608, v13
    v_lshlrev_b32 v17, 4, v5
    s_lshl_b32 s55, s52, 9
    s_add_u32 s55, s55, 589824
    s_mov_b32 s7, 0
L_wf32:
    ds_read_b32 v4, v16 offset:20
    s_add_u32 s7, s7, 1
    s_cmp_gt_u32 s7, 4194304
    s_waitcnt lgkmcnt(0)
    s_cbranch_scc1 L_wfd33
    v_cmp_ne_u32 vcc, 0, v4
    s_cbranch_vccnz L_wfd33
    s_branch L_wf32
L_wfd33:
    buffer_load_dwordx4 v[20:23], v17, s[12:15], s55 offen sc1
    s_barrier
    s_waitcnt vmcnt(0)
    s_mov_b32 s58, 0
    v_xor_b32 v20, s40, v20
    v_xor_b32 v21, s41, v21
    v_xor_b32 v22, s42, v22
    v_xor_b32 v23, s43, v23
    v_or3_b32 v4, v20, v21, v22
    v_or3_b32 v4, v4, v23, v23
    v_cmp_ne_u32_sdwa vcc, v4, 0 src0_sel:BYTE_0 src1_sel:DWORD
    s_cbranch_vccz L_ok36
L_retry34:
    s_mov_b64 exec, vcc
    buffer_load_dwordx4 v[20:23], v17, s[12:15], s55 offen sc1
    s_add_u32 s58, s58, 1
    s_cmp_gt_u32 s58, 262144
    s_waitcnt vmcnt(0)
    s_cbranch_scc1 L_rex35
    v_xor_b32 v20, s40, v20
    v_xor_b32 v21, s41, v21
    v_xor_b32 v22, s42, v22
    v_xor_b32 v23, s43, v23
    v_or3_b32 v4, v20, v21, v22
    v_or3_b32 v4, v4, v23, v23
    v_cmp_ne_u32_sdwa vcc, v4, 0 src0_sel:BYTE_0 src1_sel:DWORD
    s_cbranch_vccnz L_retry34
L_rex35:
    s_mov_b64 exec, -1
L_ok36:
    s_getreg_b32 s5, hwreg(HW_REG_XCC_ID, 0, 4)
    s_lshl_b32 s5, s5, 8
    v_cmp_ne_u32 vcc, s5, v20
    s_mov_b64 s[62:63], vcc
    s_mov_b64 exec, 0xffffffff
L_HF2:
    s_barrier
    ds_read_b128 v[20:23], v15 offset:2048
    ds_read_b128 v[24:27], v15 offset:2560
    ds_read_b128 v[28:31], v15 offset:3072
    ds_read_b128 v[32:35], v15 offset:3584
    s_waitcnt lgkmcnt(2)
    v_pk_add_f32 v[20:21], v[20:21], v[24:25]
    v_pk_add_f32 v[22:23], v[22:23], v[26:27]
    s_waitcnt lgkmcnt(0)
    v_pk_add_f32 v[28:29], v[28:29], v[32:33]
    v_pk_add_f32 v[30:31], v[30:31], v[34:35]
    v_pk_add_f32 v[20:21], v[20:21], v[28:29]
    v_pk_add_f32 v[22:23], v[22:23], v[30:31]
    s_cmp_eq_u64 s[62:63], 0
    v_perm_b32 v20, v20, v12, s44
    v_perm_b32 v21, v21, v12, s45
    v_perm_b32 v22, v22, v12, s46
    v_perm_b32 v23, v23, v12, s47
    s_cbranch_scc0 L_far
    buffer_store_dwordx4 v[20:23], v14, s[12:15], s54 offen nt
    s_branch L_near
L_far:
    buffer_store_dwordx4 v[20:23], v14, s[12:15], s53 offen sc1
L_near:
    s_mov_b64 exec, -1
    s_branch L_fin
L_fin:
L_end:
    s_endpgm
.fill (16640 - (. - parallel_sum__sliding_block_cached__geglu_ffn__decode_kernel)) / 4, 4, 0xbf810000
.section .rodata,"a"
.p2align 6
.amdhsa_kernel parallel_sum__sliding_block_cached__geglu_ffn__decode_kernel
  .amdhsa_next_free_vgpr 256
  .amdhsa_next_free_sgpr 102
  .amdhsa_accum_offset 256
  .amdhsa_group_segment_fixed_size 0
  .amdhsa_kernarg_size 96
  .amdhsa_user_sgpr_count 2
  .amdhsa_user_sgpr_kernarg_segment_ptr 1
  .amdhsa_system_sgpr_workgroup_id_x 1
  .amdhsa_float_denorm_mode_32 3
.end_amdhsa_kernel
```
